```python
import torch

def _softmax(x, axis=-1):
    return torch.softmax(x, dim=axis)
def _gelu(x):
    return torch.nn.functional.gelu(x, approximate="tanh")
def _silu(x):
    return torch.nn.functional.silu(x)
def _sigmoid(x):
    return torch.sigmoid(x)
def _layernorm(x, axis=-1, eps=1e-5):
    m = x.mean(dim=axis, keepdim=True)
    v = x.var(dim=axis, keepdim=True, unbiased=False)
    return (x - m) / torch.sqrt(v + eps)
def _scatter_add(tgt, idx, src, axis=0):
    return tgt.clone().index_add_(axis, idx, src)
def _segment_sum(src, seg, n):
    out = torch.zeros((n,) + src.shape[1:], dtype=src.dtype)
    return out.index_add_(0, seg, src)
def _pad(x, pw):
    flat = tuple(v for pair in reversed(pw) for v in pair)
    return torch.nn.functional.pad(x, flat)

kernel_name = 'parallel_sum__mha_block_cached__glu_gated_bilinear__decode'

def setup_inputs():

    _w = (lambda a: (lambda t: t.to(torch.bfloat16) if t.is_floating_point() else t)(torch.as_tensor(a)))
    def _A_setup():
        B, Sq, D = 4, 1, 640
        H, Sk, Dh = 32, 4096, 128
        return {
            "x": _w((lambda *s: torch.randn(*s, dtype=torch.bfloat16) * 0.05)(B, Sq, D)),
            "k_cache": _w((lambda *s: torch.randn(*s, dtype=torch.bfloat16) * 1.6)(B, H, Sk, Dh)),
            "v_cache": _w((lambda *s: torch.randn(*s, dtype=torch.bfloat16) * 0.8)(B, H, Sk, Dh)),
            "wq": _w((lambda *s: torch.randn(*s, dtype=torch.bfloat16) * 1.6)(D, H * Dh) * (D ** -0.5)),
            "wo": _w((lambda *s: torch.randn(*s, dtype=torch.bfloat16) * 0.8)(H * Dh, D) * ((H * Dh) ** -0.5)),
        }
    _A_in = _A_setup()

    def _B_setup():
        B, S, D, F = 4, 1, 640, 1728
        return {
            "x": _w((lambda *s: torch.randn(*s, dtype=torch.bfloat16) * 0.05)(B, S, D)),
            "w_gate": _w((lambda *s: torch.randn(*s, dtype=torch.bfloat16) * 0.4)(D, F) * (D ** -0.5)),
            "w_up": _w((lambda *s: torch.randn(*s, dtype=torch.bfloat16) * 0.4)(D, F) * (D ** -0.5)),
            "w_down": _w((lambda *s: torch.randn(*s, dtype=torch.bfloat16) * 0.4)(F, D) * (F ** -0.5)),
        }
    _B_in = _B_setup()

    return {
        "A_x": _A_in["x"],
        "A_k_cache": _A_in["k_cache"],
        "A_v_cache": _A_in["v_cache"],
        "A_wq": _A_in["wq"],
        "A_wo": _A_in["wo"],
        "B_x": _B_in["x"],
        "B_w_gate": _B_in["w_gate"],
        "B_w_up": _B_in["w_up"],
        "B_w_down": _B_in["w_down"],
    }

def reference(A_x, A_k_cache, A_v_cache, A_wq, A_wo, B_x, B_w_gate, B_w_up, B_w_down):
    def _A_ref(x, k_cache, v_cache, wq, wo):
        B, Sq, D = x.shape
        H, Dh = 32, 128
        q = (lambda x, *d: x.permute(*d))((x @ wq).reshape(B, Sq, H, Dh), 0, 2, 1, 3)
        scores = torch.einsum("bhqd,bhkd->bhqk", q, k_cache) * (Dh ** -0.5)
        p = _softmax(scores, axis=-1)
        o = torch.einsum("bhqk,bhkd->bhqd", p, v_cache)
        return (lambda x, *d: x.permute(*d))(o, 0, 2, 1, 3).reshape(B, Sq, H * Dh) @ wo

    def _B_ref(x, w_gate, w_up, w_down):
        g = torch.einsum("bsd,df->bsf", x, w_gate)
        u = torch.einsum("bsd,df->bsf", x, w_up)
        h = g * u
        return torch.einsum("bsf,fd->bsd", h, w_down)

    x = A_x
    xn = _layernorm(x, axis=-1)
    return x + _A_ref(xn, A_k_cache, A_v_cache, A_wq, A_wo) + _B_ref(xn, B_w_gate, B_w_up, B_w_down)
```

```asm
; @launch grid=(256,1,1) block=(512,1,1) lds=37376
.amdgcn_target "amdgcn-amd-amdhsa--gfx950"
.text
.globl parallel_sum__mha_block_cached__glu_gated_bilinear__decode_kernel
.p2align 8
.type parallel_sum__mha_block_cached__glu_gated_bilinear__decode_kernel,@function
parallel_sum__mha_block_cached__glu_gated_bilinear__decode_kernel:
    s_cmp_ge_u32 s2, 256
    s_cbranch_scc1 L_end
    s_load_dwordx16 s[4:19], s[0:1], 0
    s_load_dwordx8 s[20:27], s[0:1], 64
    s_getpc_b64 s[66:67]
    v_lshrrev_b32 v89, 2, v0
    v_and_b32 v89, 0x70, v89
    v_and_or_b32 v89, v0, 15, v89
    v_lshlrev_b32 v89, 7, v89
    global_load_dword v58, v89, s[66:67]
    v_and_b32 v1, 63, v0
    v_lshrrev_b32 v84, 6, v0
    v_lshrrev_b32 v85, 4, v1
    v_and_b32 v86, 15, v1
    v_readfirstlane_b32 s56, v84
    s_lshr_b32 s63, s2, 6
    s_and_b32 s62, s2, 7
    s_lshl_b32 s57, s62, 2
    s_or_b32 s57, s57, s63
    s_lshl_b32 s60, s63, 3
    s_or_b32 s60, s60, s62
    s_lshr_b32 s58, s2, 4
    s_and_b32 s58, s58, 3
    s_lshr_b32 s59, s2, 3
    s_and_b32 s59, s59, 1
    s_lshl_b32 s60, s60, 1
    s_or_b32 s60, s60, s59
    s_sub_u32 s62, s60, 16
    s_cmp_ge_u32 s60, 54
    s_cselect_b32 s61, s62, s60
    s_lshl_b32 s88, s58, 6
    s_lshl_b32 s62, s57, 1
    s_or_b32 s88, s88, s62
    s_or_b32 s88, s88, s59
    v_mul_u32_u24 v87, 80, v84
    v_add_u32 v88, v87, v85
    v_lshlrev_b32 v6, 13, v88
    v_lshl_add_u32 v6, v86, 4, v6
    v_lshlrev_b32 v12, 2, v1
    v_lshl_add_u32 v13, v87, 1, v12
    v_lshlrev_b32 v90, 12, v84
    v_lshl_add_u32 v3, v1, 4, v90
    v_bfe_u32 v91, v1, 2, 2
    v_lshl_add_u32 v2, v91, 8, v90
    v_lshl_add_u32 v2, v85, 6, v2
    v_and_b32 v91, 3, v1
    v_lshl_add_u32 v2, v91, 4, v2
    s_lshl_b32 s62, s88, 19
    s_mul_i32 s63, s58, 1280
    s_lshl_b32 s64, s57, 8
    s_mov_b32 s31, 0x20000
    s_mov_b32 s35, 0x20000
    s_mov_b32 s39, 0x20000
    s_mov_b32 s43, 0x20000
    s_mov_b32 s47, 0x20000
    s_mov_b32 s51, 0x20000
    s_mov_b32 s55, 0x20000
    s_mov_b32 s95, 0x20000
    s_mov_b32 s50, 1280
    s_sub_u32 s38, 5242880, s64
    s_mov_b32 s30, 0x80000
    s_mov_b32 s34, 0x80000
    s_mov_b32 s54, 0xd000
    s_movk_i32 s94, 256
    s_waitcnt lgkmcnt(0)
    s_add_u32 s48, s4, s63
    s_addc_u32 s49, s5, 0
    buffer_load_dword v52, v12, s[48:51], 0 offen offset:0
    buffer_load_dword v53, v12, s[48:51], 0 offen offset:256
    buffer_load_dword v54, v12, s[48:51], 0 offen offset:512
    buffer_load_dword v55, v12, s[48:51], 0 offen offset:768
    buffer_load_dword v56, v12, s[48:51], 0 offen offset:1024
    buffer_load_dword v57, v13, s[48:51], 0 offen
    s_add_u32 s28, s6, s62
    s_addc_u32 s29, s7, 0
    s_add_u32 s36, s10, s64
    s_addc_u32 s37, s11, 0
    s_add_u32 s32, s8, s62
    s_addc_u32 s33, s9, 0
    s_mov_b32 s52, s26
    s_mov_b32 s53, s27
    s_mov_b32 s92, s24
    s_mov_b32 s93, s25
    s_cmp_eq_u32 s2, 0
    s_cbranch_scc0 L_role1
    v_mov_b32 v72, 0
    v_mov_b32 v73, 0
    v_mov_b32 v74, 0
    v_mov_b32 v75, 0
    v_lshlrev_b32 v76, 4, v0
    v_add_u32 v76, 0x1000, v76
    buffer_store_dwordx4 v[72:75], v76, s[52:55], 0 offen sc0 sc1
    s_nop 1
    v_add_u32 v76, 0x2000, v76
    buffer_store_dwordx4 v[72:75], v76, s[52:55], 0 offen sc0 sc1
    s_nop 1
    v_add_u32 v76, 0x2000, v76
    buffer_store_dwordx4 v[72:75], v76, s[52:55], 0 offen sc0 sc1
    s_nop 1
    v_add_u32 v76, 0x2000, v76
    buffer_store_dwordx4 v[72:75], v76, s[52:55], 0 offen sc0 sc1
    s_nop 1
    v_add_u32 v76, 0x2000, v76
    buffer_store_dwordx4 v[72:75], v76, s[52:55], 0 offen sc0 sc1
    s_nop 1
    v_add_u32 v76, 0x2000, v76
    buffer_store_dwordx4 v[72:75], v76, s[52:55], 0 offen sc0 sc1
L_role1:
    buffer_load_dwordx4 v[92:95], v2, s[28:31], 0 offen offset:0 nt
    buffer_load_dwordx4 v[96:99], v2, s[28:31], 0 offen offset:1024 nt
    buffer_load_dwordx4 v[100:103], v2, s[28:31], 0 offen offset:2048 nt
    buffer_load_dwordx4 v[104:107], v2, s[28:31], 0 offen offset:3072 nt
    buffer_load_dwordx4 v[108:111], v6, s[36:39], 0 offen
    s_mov_b32 s68, 0x8000
    buffer_load_dwordx4 v[112:115], v6, s[36:39], s68 offen
    s_mov_b32 s69, 0x10000
    buffer_load_dwordx4 v[116:119], v6, s[36:39], s69 offen
    s_mov_b32 s70, 0x18000
    buffer_load_dwordx4 v[120:123], v6, s[36:39], s70 offen
    buffer_load_dwordx4 v[124:127], v3, s[32:35], 0 offen offset:0 nt
    buffer_load_dwordx4 v[128:131], v3, s[32:35], 0 offen offset:1024 nt
    buffer_load_dwordx4 v[132:135], v3, s[32:35], 0 offen offset:2048 nt
    buffer_load_dwordx4 v[136:139], v3, s[32:35], 0 offen offset:3072 nt
    s_mov_b32 s71, 0x20000
    buffer_load_dwordx4 v[140:143], v6, s[36:39], s71 offen
    s_mov_b32 s72, 0x28000
    buffer_load_dwordx4 v[144:147], v6, s[36:39], s72 offen
    s_mov_b32 s73, 0x30000
    buffer_load_dwordx4 v[148:151], v6, s[36:39], s73 offen
    s_mov_b32 s74, 0x38000
    buffer_load_dwordx4 v[152:155], v6, s[36:39], s74 offen
    buffer_load_dwordx4 v[156:159], v2, s[28:31], s68 offen offset:0 nt
    buffer_load_dwordx4 v[160:163], v2, s[28:31], s68 offen offset:1024 nt
    buffer_load_dwordx4 v[164:167], v2, s[28:31], s68 offen offset:2048 nt
    buffer_load_dwordx4 v[168:171], v2, s[28:31], s68 offen offset:3072 nt
    s_mov_b32 s75, 0x40000
    buffer_load_dwordx4 v[172:175], v6, s[36:39], s75 offen
    s_mov_b32 s68, 0x48000
    buffer_load_dwordx4 v[176:179], v6, s[36:39], s68 offen
    s_mov_b32 s69, 0x50000
    buffer_load_dwordx4 v[180:183], v6, s[36:39], s69 offen
    s_mov_b32 s70, 0x58000
    buffer_load_dwordx4 v[184:187], v6, s[36:39], s70 offen
    s_mov_b32 s71, 0x8000
    buffer_load_dwordx4 v[188:191], v3, s[32:35], s71 offen offset:0 nt
    buffer_load_dwordx4 v[192:195], v3, s[32:35], s71 offen offset:1024 nt
    buffer_load_dwordx4 v[196:199], v3, s[32:35], s71 offen offset:2048 nt
    buffer_load_dwordx4 v[200:203], v3, s[32:35], s71 offen offset:3072 nt
    s_mov_b32 s72, 0x60000
    buffer_load_dwordx4 v[204:207], v6, s[36:39], s72 offen
    s_mov_b32 s73, 0x68000
    buffer_load_dwordx4 v[208:211], v6, s[36:39], s73 offen
    s_mov_b32 s74, 0x70000
    buffer_load_dwordx4 v[212:215], v6, s[36:39], s74 offen
    s_mov_b32 s75, 0x78000
    buffer_load_dwordx4 v[216:219], v6, s[36:39], s75 offen
    s_mul_i32 s62, s57, 163840
    s_add_u32 s40, s12, s62
    s_addc_u32 s41, s13, 0
    s_mov_b32 s42, 163840
    s_mul_i32 s62, s61, 40960
    s_add_u32 s44, s20, s62
    s_addc_u32 s45, s21, 0
    s_mov_b32 s46, 40960
    s_mov_b32 s84, 0x3fb8aa3b
    s_mov_b32 s85, 0x3db504f3
    s_mov_b32 s86, 27648
    s_mov_b32 s87, 0
    s_mov_b32 s76, 0xf000f
    s_mov_b32 s77, 0xf000f
    s_mov_b32 s78, 0xf000f0
    s_mov_b32 s79, 0xf000f0
    s_mov_b32 s80, 0xf000f00
    s_mov_b32 s81, 0xf000f00
    s_mov_b32 s82, 0xf000f000
    s_mov_b32 s83, 0xf000f000
    s_movk_i32 s62, 1280
    v_lshl_add_u32 v88, v84, 4, v85
    v_lshlrev_b32 v90, 4, v86
    v_mad_u32_u24 v7, v88, s62, v90
    v_lshl_add_u32 v88, v84, 2, v85
    v_mad_u32_u24 v8, v88, s62, v90
    v_lshl_add_u32 v88, v85, 1, v87
    v_bfe_u32 v90, v1, 3, 1
    v_add_u32 v88, v88, v90
    s_movk_i32 s62, 3456
    v_and_b32 v90, 3, v1
    v_lshlrev_b32 v90, 4, v90
    v_mad_u32_u24 v88, v88, s62, v90
    s_lshl_b32 s62, s61, 6
    v_add_u32 v88, s62, v88
    v_and_b32 v90, 4, v1
    v_cmp_ne_u32 vcc, 0, v90
    v_mov_b32 v4, s16
    v_mov_b32 v5, s17
    v_mov_b32 v90, s18
    v_mov_b32 v91, s19
    v_cndmask_b32 v4, v4, v90, vcc
    v_cndmask_b32 v5, v5, v91, vcc
    v_add_co_u32 v4, vcc, v4, v88
    s_nop 1
    v_addc_co_u32 v5, vcc, 0, v5, vcc
    v_and_b32 v88, 1, v1
    v_cmp_eq_u32 vcc, 1, v88
    v_mov_b32 v88, 0xffff
    v_mov_b32 v90, 0xffff0000
    v_cndmask_b32 v88, v88, v90, vcc
    v_bfe_u32 v90, v1, 1, 2
    v_cmp_eq_u32 vcc, 0, v90
    s_nop 1
    v_cndmask_b32 v16, 0, v88, vcc
    v_cmp_eq_u32 vcc, 1, v90
    s_nop 1
    v_cndmask_b32 v17, 0, v88, vcc
    v_cmp_eq_u32 vcc, 2, v90
    s_nop 1
    v_cndmask_b32 v18, 0, v88, vcc
    v_cmp_eq_u32 vcc, 3, v90
    s_nop 1
    v_cndmask_b32 v19, 0, v88, vcc
    v_mov_b32 v10, 0xff800000
    v_mov_b32 v14, 0
    v_mov_b32 v15, 32
    s_waitcnt vmcnt(33)
    v_lshlrev_b32 v36, 16, v52
    v_and_b32 v37, 0xffff0000, v52
    v_lshlrev_b32 v38, 16, v53
    v_and_b32 v39, 0xffff0000, v53
    v_lshlrev_b32 v40, 16, v54
    v_and_b32 v41, 0xffff0000, v54
    v_lshlrev_b32 v42, 16, v55
    v_and_b32 v43, 0xffff0000, v55
    v_lshlrev_b32 v44, 16, v56
    v_and_b32 v45, 0xffff0000, v56
    v_add_f32 v46, v36, v37
    v_add_f32 v46, v46, v38
    v_add_f32 v46, v46, v39
    v_add_f32 v46, v46, v40
    v_add_f32 v46, v46, v41
    v_add_f32 v46, v46, v42
    v_add_f32 v46, v46, v43
    v_add_f32 v46, v46, v44
    v_add_f32 v46, v46, v45
    s_nop 1
    v_add_f32_dpp v46, v46, v46 row_ror:8 row_mask:0xf bank_mask:0xf
    s_nop 1
    v_add_f32_dpp v46, v46, v46 row_ror:4 row_mask:0xf bank_mask:0xf
    s_nop 1
    v_add_f32_dpp v46, v46, v46 row_ror:2 row_mask:0xf bank_mask:0xf
    s_nop 1
    v_add_f32_dpp v46, v46, v46 row_ror:1 row_mask:0xf bank_mask:0xf
    v_mov_b32 v47, v46
    s_nop 1
    v_permlane16_swap_b32 v47, v46
    v_add_f32 v46, v47, v46
    v_mov_b32 v47, v46
    s_nop 1
    v_permlane32_swap_b32 v47, v46
    v_add_f32 v46, v47, v46
    v_mul_f32 v46, 0x3acccccd, v46
    v_sub_f32 v36, v36, v46
    v_mul_f32 v48, v36, v36
    v_sub_f32 v37, v37, v46
    v_fmac_f32 v48, v37, v37
    v_sub_f32 v38, v38, v46
    v_fmac_f32 v48, v38, v38
    v_sub_f32 v39, v39, v46
    v_fmac_f32 v48, v39, v39
    v_sub_f32 v40, v40, v46
    v_fmac_f32 v48, v40, v40
    v_sub_f32 v41, v41, v46
    v_fmac_f32 v48, v41, v41
    v_sub_f32 v42, v42, v46
    v_fmac_f32 v48, v42, v42
    v_sub_f32 v43, v43, v46
    v_fmac_f32 v48, v43, v43
    v_sub_f32 v44, v44, v46
    v_fmac_f32 v48, v44, v44
    v_sub_f32 v45, v45, v46
    v_fmac_f32 v48, v45, v45
    s_nop 1
    v_add_f32_dpp v48, v48, v48 row_ror:8 row_mask:0xf bank_mask:0xf
    s_nop 1
    v_add_f32_dpp v48, v48, v48 row_ror:4 row_mask:0xf bank_mask:0xf
    s_nop 1
    v_add_f32_dpp v48, v48, v48 row_ror:2 row_mask:0xf bank_mask:0xf
    s_nop 1
    v_add_f32_dpp v48, v48, v48 row_ror:1 row_mask:0xf bank_mask:0xf
    v_mov_b32 v47, v48
    s_nop 1
    v_permlane16_swap_b32 v47, v48
    v_add_f32 v48, v47, v48
    v_mov_b32 v47, v48
    s_nop 1
    v_permlane32_swap_b32 v47, v48
    v_add_f32 v48, v47, v48
    v_mul_f32 v48, 0x3acccccd, v48
    v_cvt_pk_bf16_f32 v49, v46, v48
    v_lshlrev_b32 v46, 16, v49
    v_and_b32 v48, 0xffff0000, v49
    v_add_f32 v48, 0x3727c5ac, v48
    v_cvt_pk_bf16_f32 v49, v48, v48
    v_lshlrev_b32 v48, 16, v49
    v_sqrt_f32 v48, v48
    s_nop 0
    v_cvt_pk_bf16_f32 v49, v48, v48
    v_lshlrev_b32 v48, 16, v49
    v_rcp_f32 v48, v48
    s_waitcnt vmcnt(32)
    v_lshlrev_b32 v36, 16, v57
    v_and_b32 v37, 0xffff0000, v57
    v_sub_f32 v36, v36, v46
    v_sub_f32 v37, v37, v46
    v_cvt_pk_bf16_f32 v49, v36, v37
    v_lshlrev_b32 v36, 16, v49
    v_and_b32 v37, 0xffff0000, v49
    v_mul_f32 v36, v36, v48
    v_mul_f32 v37, v37, v48
    v_cvt_pk_bf16_f32 v38, v36, v36
    v_cvt_pk_bf16_f32 v39, v37, v37
    v_lshlrev_b32 v88, 9, v84
    v_lshl_add_u32 v90, v1, 3, v88
    ds_write_b64 v90, v[38:39] offset:0
    v_lshl_add_u32 v90, v86, 2, v85
    v_lshl_add_u32 v90, v90, 2, v88
    s_waitcnt lgkmcnt(0)
    ds_read2_b32 v[12:13], v90 offset0:0 offset1:64
    s_waitcnt lgkmcnt(0)
    v_and_b32_dpp v72, v12, v16 row_newbcast:0 row_mask:0xf bank_mask:0xf
    v_and_b32_dpp v73, v12, v17 row_newbcast:0 row_mask:0xf bank_mask:0xf
    v_and_b32_dpp v74, v12, v18 row_newbcast:0 row_mask:0xf bank_mask:0xf
    v_and_b32_dpp v75, v12, v19 row_newbcast:0 row_mask:0xf bank_mask:0xf
    v_and_b32_dpp v76, v12, v16 row_newbcast:1 row_mask:0xf bank_mask:0xf
    v_and_b32_dpp v77, v12, v17 row_newbcast:1 row_mask:0xf bank_mask:0xf
    v_and_b32_dpp v78, v12, v18 row_newbcast:1 row_mask:0xf bank_mask:0xf
    v_and_b32_dpp v79, v12, v19 row_newbcast:1 row_mask:0xf bank_mask:0xf
    s_waitcnt vmcnt(27)
    v_mfma_f32_16x16x32_bf16 v[80:83], v[72:75], v[108:111], 0
    s_mov_b32 s68, 0x10000
    buffer_load_dwordx4 v[108:111], v2, s[28:31], s68 offen offset:0 nt
    v_and_b32_dpp v72, v12, v16 row_newbcast:2 row_mask:0xf bank_mask:0xf
    v_and_b32_dpp v73, v12, v17 row_newbcast:2 row_mask:0xf bank_mask:0xf
    v_and_b32_dpp v74, v12, v18 row_newbcast:2 row_mask:0xf bank_mask:0xf
    v_and_b32_dpp v75, v12, v19 row_newbcast:2 row_mask:0xf bank_mask:0xf
    s_waitcnt vmcnt(27)
    v_mfma_f32_16x16x32_bf16 v[80:83], v[76:79], v[112:115], v[80:83]
    buffer_load_dwordx4 v[112:115], v2, s[28:31], s68 offen offset:1024 nt
    v_and_b32_dpp v76, v12, v16 row_newbcast:3 row_mask:0xf bank_mask:0xf
    v_and_b32_dpp v77, v12, v17 row_newbcast:3 row_mask:0xf bank_mask:0xf
    v_and_b32_dpp v78, v12, v18 row_newbcast:3 row_mask:0xf bank_mask:0xf
    v_and_b32_dpp v79, v12, v19 row_newbcast:3 row_mask:0xf bank_mask:0xf
    s_waitcnt vmcnt(27)
    v_mfma_f32_16x16x32_bf16 v[80:83], v[72:75], v[116:119], v[80:83]
    buffer_load_dwordx4 v[116:119], v2, s[28:31], s68 offen offset:2048 nt
    v_and_b32_dpp v72, v12, v16 row_newbcast:4 row_mask:0xf bank_mask:0xf
    v_and_b32_dpp v73, v12, v17 row_newbcast:4 row_mask:0xf bank_mask:0xf
    v_and_b32_dpp v74, v12, v18 row_newbcast:4 row_mask:0xf bank_mask:0xf
    v_and_b32_dpp v75, v12, v19 row_newbcast:4 row_mask:0xf bank_mask:0xf
    s_waitcnt vmcnt(27)
    v_mfma_f32_16x16x32_bf16 v[80:83], v[76:79], v[120:123], v[80:83]
    buffer_load_dwordx4 v[120:123], v2, s[28:31], s68 offen offset:3072 nt
    v_and_b32_dpp v76, v12, v16 row_newbcast:5 row_mask:0xf bank_mask:0xf
    v_and_b32_dpp v77, v12, v17 row_newbcast:5 row_mask:0xf bank_mask:0xf
    v_and_b32_dpp v78, v12, v18 row_newbcast:5 row_mask:0xf bank_mask:0xf
    v_and_b32_dpp v79, v12, v19 row_newbcast:5 row_mask:0xf bank_mask:0xf
    s_waitcnt vmcnt(23)
    v_mfma_f32_16x16x32_bf16 v[80:83], v[72:75], v[140:143], v[80:83]
    s_mov_b32 s69, 0x80000
    buffer_load_dwordx4 v[140:143], v6, s[36:39], s69 offen
    v_and_b32_dpp v72, v12, v16 row_newbcast:6 row_mask:0xf bank_mask:0xf
    v_and_b32_dpp v73, v12, v17 row_newbcast:6 row_mask:0xf bank_mask:0xf
    v_and_b32_dpp v74, v12, v18 row_newbcast:6 row_mask:0xf bank_mask:0xf
    v_and_b32_dpp v75, v12, v19 row_newbcast:6 row_mask:0xf bank_mask:0xf
    s_waitcnt vmcnt(23)
    v_mfma_f32_16x16x32_bf16 v[80:83], v[76:79], v[144:147], v[80:83]
    s_mov_b32 s70, 0x88000
    buffer_load_dwordx4 v[144:147], v6, s[36:39], s70 offen
    v_and_b32_dpp v76, v12, v16 row_newbcast:7 row_mask:0xf bank_mask:0xf
    v_and_b32_dpp v77, v12, v17 row_newbcast:7 row_mask:0xf bank_mask:0xf
    v_and_b32_dpp v78, v12, v18 row_newbcast:7 row_mask:0xf bank_mask:0xf
    v_and_b32_dpp v79, v12, v19 row_newbcast:7 row_mask:0xf bank_mask:0xf
    s_waitcnt vmcnt(23)
    v_mfma_f32_16x16x32_bf16 v[80:83], v[72:75], v[148:151], v[80:83]
    s_mov_b32 s71, 0x90000
    buffer_load_dwordx4 v[148:151], v6, s[36:39], s71 offen
    v_and_b32_dpp v72, v12, v16 row_newbcast:8 row_mask:0xf bank_mask:0xf
    v_and_b32_dpp v73, v12, v17 row_newbcast:8 row_mask:0xf bank_mask:0xf
    v_and_b32_dpp v74, v12, v18 row_newbcast:8 row_mask:0xf bank_mask:0xf
    v_and_b32_dpp v75, v12, v19 row_newbcast:8 row_mask:0xf bank_mask:0xf
    s_waitcnt vmcnt(23)
    v_mfma_f32_16x16x32_bf16 v[80:83], v[76:79], v[152:155], v[80:83]
    s_mov_b32 s72, 0x98000
    buffer_load_dwordx4 v[152:155], v6, s[36:39], s72 offen
    v_and_b32_dpp v76, v12, v16 row_newbcast:9 row_mask:0xf bank_mask:0xf
    v_and_b32_dpp v77, v12, v17 row_newbcast:9 row_mask:0xf bank_mask:0xf
    v_and_b32_dpp v78, v12, v18 row_newbcast:9 row_mask:0xf bank_mask:0xf
    v_and_b32_dpp v79, v12, v19 row_newbcast:9 row_mask:0xf bank_mask:0xf
    s_waitcnt vmcnt(19)
    v_mfma_f32_16x16x32_bf16 v[80:83], v[72:75], v[172:175], v[80:83]
    buffer_load_dwordx4 v[172:175], v3, s[32:35], s68 offen offset:0 nt
    v_and_b32_dpp v72, v12, v16 row_newbcast:10 row_mask:0xf bank_mask:0xf
    v_and_b32_dpp v73, v12, v17 row_newbcast:10 row_mask:0xf bank_mask:0xf
    v_and_b32_dpp v74, v12, v18 row_newbcast:10 row_mask:0xf bank_mask:0xf
    v_and_b32_dpp v75, v12, v19 row_newbcast:10 row_mask:0xf bank_mask:0xf
    s_waitcnt vmcnt(19)
    v_mfma_f32_16x16x32_bf16 v[80:83], v[76:79], v[176:179], v[80:83]
    buffer_load_dwordx4 v[176:179], v3, s[32:35], s68 offen offset:1024 nt
    v_and_b32_dpp v76, v12, v16 row_newbcast:11 row_mask:0xf bank_mask:0xf
    v_and_b32_dpp v77, v12, v17 row_newbcast:11 row_mask:0xf bank_mask:0xf
    v_and_b32_dpp v78, v12, v18 row_newbcast:11 row_mask:0xf bank_mask:0xf
    v_and_b32_dpp v79, v12, v19 row_newbcast:11 row_mask:0xf bank_mask:0xf
    s_waitcnt vmcnt(19)
    v_mfma_f32_16x16x32_bf16 v[80:83], v[72:75], v[180:183], v[80:83]
    buffer_load_dwordx4 v[180:183], v3, s[32:35], s68 offen offset:2048 nt
    v_and_b32_dpp v72, v12, v16 row_newbcast:12 row_mask:0xf bank_mask:0xf
    v_and_b32_dpp v73, v12, v17 row_newbcast:12 row_mask:0xf bank_mask:0xf
    v_and_b32_dpp v74, v12, v18 row_newbcast:12 row_mask:0xf bank_mask:0xf
    v_and_b32_dpp v75, v12, v19 row_newbcast:12 row_mask:0xf bank_mask:0xf
    s_waitcnt vmcnt(19)
    v_mfma_f32_16x16x32_bf16 v[80:83], v[76:79], v[184:187], v[80:83]
    buffer_load_dwordx4 v[184:187], v3, s[32:35], s68 offen offset:3072 nt
    v_and_b32_dpp v76, v12, v16 row_newbcast:13 row_mask:0xf bank_mask:0xf
    v_and_b32_dpp v77, v12, v17 row_newbcast:13 row_mask:0xf bank_mask:0xf
    v_and_b32_dpp v78, v12, v18 row_newbcast:13 row_mask:0xf bank_mask:0xf
    v_and_b32_dpp v79, v12, v19 row_newbcast:13 row_mask:0xf bank_mask:0xf
    s_waitcnt vmcnt(15)
    v_mfma_f32_16x16x32_bf16 v[80:83], v[72:75], v[204:207], v[80:83]
    s_mov_b32 s73, 0x18000
    buffer_load_dwordx4 v[204:207], v2, s[28:31], s73 offen offset:0 nt
    v_and_b32_dpp v72, v12, v16 row_newbcast:14 row_mask:0xf bank_mask:0xf
    v_and_b32_dpp v73, v12, v17 row_newbcast:14 row_mask:0xf bank_mask:0xf
    v_and_b32_dpp v74, v12, v18 row_newbcast:14 row_mask:0xf bank_mask:0xf
    v_and_b32_dpp v75, v12, v19 row_newbcast:14 row_mask:0xf bank_mask:0xf
    s_waitcnt vmcnt(15)
    v_mfma_f32_16x16x32_bf16 v[80:83], v[76:79], v[208:211], v[80:83]
    buffer_load_dwordx4 v[208:211], v2, s[28:31], s73 offen offset:1024 nt
    v_and_b32_dpp v76, v12, v16 row_newbcast:15 row_mask:0xf bank_mask:0xf
    v_and_b32_dpp v77, v12, v17 row_newbcast:15 row_mask:0xf bank_mask:0xf
    v_and_b32_dpp v78, v12, v18 row_newbcast:15 row_mask:0xf bank_mask:0xf
    v_and_b32_dpp v79, v12, v19 row_newbcast:15 row_mask:0xf bank_mask:0xf
    s_waitcnt vmcnt(15)
    v_mfma_f32_16x16x32_bf16 v[80:83], v[72:75], v[212:215], v[80:83]
    buffer_load_dwordx4 v[212:215], v2, s[28:31], s73 offen offset:2048 nt
    v_and_b32_dpp v72, v13, v16 row_newbcast:0 row_mask:0xf bank_mask:0xf
    v_and_b32_dpp v73, v13, v17 row_newbcast:0 row_mask:0xf bank_mask:0xf
    v_and_b32_dpp v74, v13, v18 row_newbcast:0 row_mask:0xf bank_mask:0xf
    v_and_b32_dpp v75, v13, v19 row_newbcast:0 row_mask:0xf bank_mask:0xf
    s_waitcnt vmcnt(15)
    v_mfma_f32_16x16x32_bf16 v[80:83], v[76:79], v[216:219], v[80:83]
    buffer_load_dwordx4 v[216:219], v2, s[28:31], s73 offen offset:3072 nt
    v_and_b32_dpp v76, v13, v16 row_newbcast:1 row_mask:0xf bank_mask:0xf
    v_and_b32_dpp v77, v13, v17 row_newbcast:1 row_mask:0xf bank_mask:0xf
    v_and_b32_dpp v78, v13, v18 row_newbcast:1 row_mask:0xf bank_mask:0xf
    v_and_b32_dpp v79, v13, v19 row_newbcast:1 row_mask:0xf bank_mask:0xf
    s_waitcnt vmcnt(11)
    v_mfma_f32_16x16x32_bf16 v[80:83], v[72:75], v[140:143], v[80:83]
    buffer_load_dwordx4 v[140:143], v3, s[32:35], s73 offen offset:0 nt
    v_and_b32_dpp v72, v13, v16 row_newbcast:2 row_mask:0xf bank_mask:0xf
    v_and_b32_dpp v73, v13, v17 row_newbcast:2 row_mask:0xf bank_mask:0xf
    v_and_b32_dpp v74, v13, v18 row_newbcast:2 row_mask:0xf bank_mask:0xf
    v_and_b32_dpp v75, v13, v19 row_newbcast:2 row_mask:0xf bank_mask:0xf
    s_waitcnt vmcnt(11)
    v_mfma_f32_16x16x32_bf16 v[80:83], v[76:79], v[144:147], v[80:83]
    buffer_load_dwordx4 v[144:147], v3, s[32:35], s73 offen offset:1024 nt
    v_and_b32_dpp v76, v13, v16 row_newbcast:3 row_mask:0xf bank_mask:0xf
    v_and_b32_dpp v77, v13, v17 row_newbcast:3 row_mask:0xf bank_mask:0xf
    v_and_b32_dpp v78, v13, v18 row_newbcast:3 row_mask:0xf bank_mask:0xf
    v_and_b32_dpp v79, v13, v19 row_newbcast:3 row_mask:0xf bank_mask:0xf
    s_waitcnt vmcnt(11)
    v_mfma_f32_16x16x32_bf16 v[80:83], v[72:75], v[148:151], v[80:83]
    buffer_load_dwordx4 v[148:151], v3, s[32:35], s73 offen offset:2048 nt
    s_waitcnt vmcnt(11)
    v_mfma_f32_16x16x32_bf16 v[80:83], v[76:79], v[152:155], v[80:83]
    buffer_load_dwordx4 v[152:155], v3, s[32:35], s73 offen offset:3072 nt
    v_and_b32 v90, 1, v85
    v_lshl_add_u32 v90, v86, 1, v90
    v_lshlrev_b32 v87, 4, v90
    v_add_u32 v90, v87, v88
    s_mov_b32 exec_lo, 0xffffffff
    s_mov_b32 exec_hi, 0x0
    s_nop 0
    ds_write_b128 v90, v[80:83] offset:4096
    s_mov_b64 exec, -1
    s_cmp_eq_u32 s2, 0
    s_cbranch_scc0 L_role2
    s_waitcnt vmcnt(52)
    v_mov_b32 v14, 1
    v_mov_b32 v15, 32
    s_mov_b32 exec_lo, 0x1
    s_mov_b32 exec_hi, 0x0
    buffer_atomic_add v14, v15, s[92:95], 0 offen sc1
    s_mov_b64 exec, -1
L_role2:
    s_mul_i32 s63, s58, 1280
    s_add_u32 s36, s22, s63
    s_addc_u32 s37, s23, 0
    s_movk_i32 s38, 1280
    v_and_b32 v90, 3, v1
    v_lshl_add_u32 v90, v85, 2, v90
    v_lshlrev_b32 v90, 5, v90
    v_bfe_u32 v91, v1, 2, 2
    v_lshl_add_u32 v90, v91, 10, v90
    s_waitcnt lgkmcnt(0)
    s_barrier
    ds_read_b128 v[36:39], v90 offset:4096
    ds_read_b128 v[40:43], v90 offset:4112
    ds_read_b128 v[44:47], v90 offset:4608
    ds_read_b128 v[48:51], v90 offset:4624
    s_waitcnt lgkmcnt(0)
    v_add_f32 v36, v36, v44
    v_add_f32 v37, v37, v45
    v_add_f32 v38, v38, v46
    v_add_f32 v39, v39, v47
    v_add_f32 v40, v40, v48
    v_add_f32 v41, v41, v49
    v_add_f32 v42, v42, v50
    v_add_f32 v43, v43, v51
    v_add_f32_dpp v36, v36, v36 row_ror:8 row_mask:0xf bank_mask:0xf
    v_add_f32_dpp v37, v37, v37 row_ror:8 row_mask:0xf bank_mask:0xf
    v_add_f32_dpp v38, v38, v38 row_ror:8 row_mask:0xf bank_mask:0xf
    v_add_f32_dpp v39, v39, v39 row_ror:8 row_mask:0xf bank_mask:0xf
    v_add_f32_dpp v40, v40, v40 row_ror:8 row_mask:0xf bank_mask:0xf
    v_add_f32_dpp v41, v41, v41 row_ror:8 row_mask:0xf bank_mask:0xf
    v_add_f32_dpp v42, v42, v42 row_ror:8 row_mask:0xf bank_mask:0xf
    v_add_f32_dpp v43, v43, v43 row_ror:8 row_mask:0xf bank_mask:0xf
    v_add_f32_dpp v36, v36, v36 row_ror:4 row_mask:0xf bank_mask:0xf
    v_add_f32_dpp v37, v37, v37 row_ror:4 row_mask:0xf bank_mask:0xf
    v_add_f32_dpp v38, v38, v38 row_ror:4 row_mask:0xf bank_mask:0xf
    v_add_f32_dpp v39, v39, v39 row_ror:4 row_mask:0xf bank_mask:0xf
    v_add_f32_dpp v40, v40, v40 row_ror:4 row_mask:0xf bank_mask:0xf
    v_add_f32_dpp v41, v41, v41 row_ror:4 row_mask:0xf bank_mask:0xf
    v_add_f32_dpp v42, v42, v42 row_ror:4 row_mask:0xf bank_mask:0xf
    v_add_f32_dpp v43, v43, v43 row_ror:4 row_mask:0xf bank_mask:0xf
    v_cvt_pk_bf16_f32 v44, v36, v37
    v_cvt_pk_bf16_f32 v45, v38, v39
    v_cvt_pk_bf16_f32 v46, v40, v41
    v_cvt_pk_bf16_f32 v47, v42, v43
    v_cndmask_b32_e64 v20, 0, v44, s[76:77]
    v_cndmask_b32_e64 v21, 0, v45, s[76:77]
    v_cndmask_b32_e64 v22, 0, v46, s[76:77]
    v_cndmask_b32_e64 v23, 0, v47, s[76:77]
    v_cndmask_b32_e64 v24, 0, v44, s[78:79]
    v_cndmask_b32_e64 v25, 0, v45, s[78:79]
    v_cndmask_b32_e64 v26, 0, v46, s[78:79]
    v_cndmask_b32_e64 v27, 0, v47, s[78:79]
    v_cndmask_b32_e64 v28, 0, v44, s[80:81]
    v_cndmask_b32_e64 v29, 0, v45, s[80:81]
    v_cndmask_b32_e64 v30, 0, v46, s[80:81]
    v_cndmask_b32_e64 v31, 0, v47, s[80:81]
    v_cndmask_b32_e64 v32, 0, v44, s[82:83]
    v_cndmask_b32_e64 v33, 0, v45, s[82:83]
    v_cndmask_b32_e64 v34, 0, v46, s[82:83]
    v_cndmask_b32_e64 v35, 0, v47, s[82:83]
    v_mfma_f32_16x16x32_bf16 v[36:39], v[92:95], v[20:23], 0
    v_mfma_f32_16x16x32_bf16 v[36:39], v[96:99], v[24:27], v[36:39]
    v_mfma_f32_16x16x32_bf16 v[36:39], v[100:103], v[28:31], v[36:39]
    v_mfma_f32_16x16x32_bf16 v[36:39], v[104:107], v[32:35], v[36:39]
    global_load_dwordx4 v[92:95], v[4:5], off
    v_lshl_add_u64 v[4:5], v[4:5], 0, s[86:87]
    global_load_dwordx4 v[96:99], v[4:5], off
    v_lshl_add_u64 v[4:5], v[4:5], 0, s[86:87]
    global_load_dwordx4 v[100:103], v[4:5], off
    v_lshl_add_u64 v[4:5], v[4:5], 0, s[86:87]
    global_load_dwordx4 v[104:107], v[4:5], off
    v_lshl_add_u64 v[4:5], v[4:5], 0, s[86:87]
    v_mfma_f32_16x16x32_bf16 v[40:43], v[156:159], v[20:23], 0
    v_mfma_f32_16x16x32_bf16 v[40:43], v[160:163], v[24:27], v[40:43]
    v_mfma_f32_16x16x32_bf16 v[40:43], v[164:167], v[28:31], v[40:43]
    v_mfma_f32_16x16x32_bf16 v[40:43], v[168:171], v[32:35], v[40:43]
    global_load_dwordx4 v[156:159], v[4:5], off
    v_lshl_add_u64 v[4:5], v[4:5], 0, s[86:87]
    global_load_dwordx4 v[160:163], v[4:5], off
    v_lshl_add_u64 v[4:5], v[4:5], 0, s[86:87]
    global_load_dwordx4 v[164:167], v[4:5], off
    v_lshl_add_u64 v[4:5], v[4:5], 0, s[86:87]
    global_load_dwordx4 v[168:171], v[4:5], off
    v_lshl_add_u64 v[4:5], v[4:5], 0, s[86:87]
    v_mfma_f32_16x16x32_bf16 v[44:47], v[108:111], v[20:23], 0
    v_mfma_f32_16x16x32_bf16 v[44:47], v[112:115], v[24:27], v[44:47]
    v_mfma_f32_16x16x32_bf16 v[44:47], v[116:119], v[28:31], v[44:47]
    v_mfma_f32_16x16x32_bf16 v[44:47], v[120:123], v[32:35], v[44:47]
    global_load_dwordx4 v[108:111], v[4:5], off
    v_lshl_add_u64 v[4:5], v[4:5], 0, s[86:87]
    global_load_dwordx4 v[112:115], v[4:5], off
    v_lshl_add_u64 v[4:5], v[4:5], 0, s[86:87]
    s_mov_b32 s74, 0x20000
    buffer_load_dwordx4 v[116:119], v2, s[28:31], s74 offen offset:0 nt
    buffer_load_dwordx4 v[120:123], v2, s[28:31], s74 offen offset:1024 nt
    s_waitcnt vmcnt(16)
    v_mfma_f32_16x16x32_bf16 v[48:51], v[204:207], v[20:23], 0
    v_mfma_f32_16x16x32_bf16 v[48:51], v[208:211], v[24:27], v[48:51]
    v_mfma_f32_16x16x32_bf16 v[48:51], v[212:215], v[28:31], v[48:51]
    v_mfma_f32_16x16x32_bf16 v[48:51], v[216:219], v[32:35], v[48:51]
    buffer_load_dwordx4 v[204:207], v2, s[28:31], s74 offen offset:2048 nt
    buffer_load_dwordx4 v[208:211], v2, s[28:31], s74 offen offset:3072 nt
    buffer_load_dwordx4 v[212:215], v3, s[32:35], s74 offen offset:0 nt
    buffer_load_dwordx4 v[216:219], v3, s[32:35], s74 offen offset:1024 nt
    v_mov_b32_dpp v52, v36 quad_perm:[0,0,0,0] row_mask:0xf bank_mask:0xf
    v_mov_b32_dpp v53, v40 quad_perm:[0,0,0,0] row_mask:0xf bank_mask:0xf
    v_mov_b32_dpp v54, v44 quad_perm:[0,0,0,0] row_mask:0xf bank_mask:0xf
    s_nop 0
    v_mov_b32_dpp v55, v48 quad_perm:[0,0,0,0] row_mask:0xf bank_mask:0xf
    v_add_f32_dpp v52, v37, v52 quad_perm:[1,1,1,1] row_mask:0xf bank_mask:0xf
    v_add_f32_dpp v53, v41, v53 quad_perm:[1,1,1,1] row_mask:0xf bank_mask:0xf
    v_add_f32_dpp v54, v45, v54 quad_perm:[1,1,1,1] row_mask:0xf bank_mask:0xf
    v_add_f32_dpp v55, v49, v55 quad_perm:[1,1,1,1] row_mask:0xf bank_mask:0xf
    v_add_f32_dpp v52, v38, v52 quad_perm:[2,2,2,2] row_mask:0xf bank_mask:0xf
    v_add_f32_dpp v53, v42, v53 quad_perm:[2,2,2,2] row_mask:0xf bank_mask:0xf
    v_add_f32_dpp v54, v46, v54 quad_perm:[2,2,2,2] row_mask:0xf bank_mask:0xf
    v_add_f32_dpp v55, v50, v55 quad_perm:[2,2,2,2] row_mask:0xf bank_mask:0xf
    v_add_f32_dpp v52, v39, v52 quad_perm:[3,3,3,3] row_mask:0xf bank_mask:0xf
    v_add_f32_dpp v53, v43, v53 quad_perm:[3,3,3,3] row_mask:0xf bank_mask:0xf
    v_add_f32_dpp v54, v47, v54 quad_perm:[3,3,3,3] row_mask:0xf bank_mask:0xf
    v_add_f32_dpp v55, v51, v55 quad_perm:[3,3,3,3] row_mask:0xf bank_mask:0xf
    v_cvt_pk_bf16_f32 v68, v52, v53
    v_cvt_pk_bf16_f32 v69, v54, v55
    v_lshlrev_b32 v52, 16, v68
    v_and_b32 v53, 0xffff0000, v68
    v_lshlrev_b32 v54, 16, v69
    v_and_b32 v55, 0xffff0000, v69
    v_mul_f32 v52, s85, v52
    v_mul_f32 v53, s85, v53
    v_mul_f32 v54, s85, v54
    v_mul_f32 v55, s85, v55
    v_cvt_pk_bf16_f32 v68, v52, v53
    v_cvt_pk_bf16_f32 v69, v54, v55
    v_lshlrev_b32 v52, 16, v68
    v_and_b32 v53, 0xffff0000, v68
    v_lshlrev_b32 v54, 16, v69
    v_and_b32 v55, 0xffff0000, v69
    v_max3_f32 v10, v10, v52, v53
    v_max3_f32 v10, v10, v54, v55
    s_nop 1
    v_max_f32_dpp v10, v10, v10 row_ror:4 row_mask:0xf bank_mask:0xf
    s_nop 1
    v_max_f32_dpp v10, v10, v10 row_ror:8 row_mask:0xf bank_mask:0xf
    v_mov_b32 v36, v10
    s_nop 1
    v_permlane16_swap_b32 v36, v10
    v_max_f32 v10, v36, v10
    v_mov_b32 v36, v10
    s_nop 1
    v_permlane32_swap_b32 v36, v10
    v_max_f32 v10, v36, v10
    v_mov_b32 v9, v10
    v_sub_f32 v52, v52, v10
    v_sub_f32 v53, v53, v10
    v_sub_f32 v54, v54, v10
    v_sub_f32 v55, v55, v10
    v_mul_f32 v52, s84, v52
    v_mul_f32 v53, s84, v53
    v_mul_f32 v54, s84, v54
    v_mul_f32 v55, s84, v55
    v_exp_f32 v52, v52
    v_exp_f32 v53, v53
    v_exp_f32 v54, v54
    v_exp_f32 v55, v55
    v_add_f32 v11, v52, v53
    v_add_f32 v36, v54, v55
    v_add_f32 v11, v11, v36
    v_cvt_pk_bf16_f32 v52, v52, v52
    v_cvt_pk_bf16_f32 v53, v53, v53
    v_cvt_pk_bf16_f32 v54, v54, v54
    v_cvt_pk_bf16_f32 v55, v55, v55
    v_and_b32_dpp v72, v52, v16 row_newbcast:0 row_mask:0xf bank_mask:0xf
    v_and_b32_dpp v73, v52, v17 row_newbcast:0 row_mask:0xf bank_mask:0xf
    v_and_b32_dpp v74, v52, v18 row_newbcast:0 row_mask:0xf bank_mask:0xf
    v_and_b32_dpp v75, v52, v19 row_newbcast:0 row_mask:0xf bank_mask:0xf
    v_and_b32_dpp v76, v52, v16 row_newbcast:4 row_mask:0xf bank_mask:0xf
    v_and_b32_dpp v77, v52, v17 row_newbcast:4 row_mask:0xf bank_mask:0xf
    v_and_b32_dpp v78, v52, v18 row_newbcast:4 row_mask:0xf bank_mask:0xf
    v_and_b32_dpp v79, v52, v19 row_newbcast:4 row_mask:0xf bank_mask:0xf
    v_mfma_f32_16x16x32_bf16 v[80:83], v[72:75], v[124:127], 0
    buffer_load_dwordx4 v[124:127], v3, s[32:35], s74 offen offset:2048 nt
    v_and_b32_dpp v72, v52, v16 row_newbcast:8 row_mask:0xf bank_mask:0xf
    v_and_b32_dpp v73, v52, v17 row_newbcast:8 row_mask:0xf bank_mask:0xf
    v_and_b32_dpp v74, v52, v18 row_newbcast:8 row_mask:0xf bank_mask:0xf
    v_and_b32_dpp v75, v52, v19 row_newbcast:8 row_mask:0xf bank_mask:0xf
    v_mfma_f32_16x16x32_bf16 v[80:83], v[76:79], v[128:131], v[80:83]
    buffer_load_dwordx4 v[128:131], v3, s[32:35], s74 offen offset:3072 nt
    v_and_b32_dpp v76, v52, v16 row_newbcast:12 row_mask:0xf bank_mask:0xf
    v_and_b32_dpp v77, v52, v17 row_newbcast:12 row_mask:0xf bank_mask:0xf
    v_and_b32_dpp v78, v52, v18 row_newbcast:12 row_mask:0xf bank_mask:0xf
    v_and_b32_dpp v79, v52, v19 row_newbcast:12 row_mask:0xf bank_mask:0xf
    v_mfma_f32_16x16x32_bf16 v[80:83], v[72:75], v[132:135], v[80:83]
    s_mov_b32 s75, 0x28000
    buffer_load_dwordx4 v[132:135], v2, s[28:31], s75 offen offset:0 nt
    v_and_b32_dpp v72, v53, v16 row_newbcast:0 row_mask:0xf bank_mask:0xf
    v_and_b32_dpp v73, v53, v17 row_newbcast:0 row_mask:0xf bank_mask:0xf
    v_and_b32_dpp v74, v53, v18 row_newbcast:0 row_mask:0xf bank_mask:0xf
    v_and_b32_dpp v75, v53, v19 row_newbcast:0 row_mask:0xf bank_mask:0xf
    v_mfma_f32_16x16x32_bf16 v[80:83], v[76:79], v[136:139], v[80:83]
    buffer_load_dwordx4 v[136:139], v2, s[28:31], s75 offen offset:1024 nt
    v_and_b32_dpp v76, v53, v16 row_newbcast:4 row_mask:0xf bank_mask:0xf
    v_and_b32_dpp v77, v53, v17 row_newbcast:4 row_mask:0xf bank_mask:0xf
    v_and_b32_dpp v78, v53, v18 row_newbcast:4 row_mask:0xf bank_mask:0xf
    v_and_b32_dpp v79, v53, v19 row_newbcast:4 row_mask:0xf bank_mask:0xf
    v_mfma_f32_16x16x32_bf16 v[80:83], v[72:75], v[188:191], v[80:83]
    buffer_load_dwordx4 v[188:191], v2, s[28:31], s75 offen offset:2048 nt
    v_and_b32_dpp v72, v53, v16 row_newbcast:8 row_mask:0xf bank_mask:0xf
    v_and_b32_dpp v73, v53, v17 row_newbcast:8 row_mask:0xf bank_mask:0xf
    v_and_b32_dpp v74, v53, v18 row_newbcast:8 row_mask:0xf bank_mask:0xf
    v_and_b32_dpp v75, v53, v19 row_newbcast:8 row_mask:0xf bank_mask:0xf
    v_mfma_f32_16x16x32_bf16 v[80:83], v[76:79], v[192:195], v[80:83]
    buffer_load_dwordx4 v[192:195], v2, s[28:31], s75 offen offset:3072 nt
    v_and_b32_dpp v76, v53, v16 row_newbcast:12 row_mask:0xf bank_mask:0xf
    v_and_b32_dpp v77, v53, v17 row_newbcast:12 row_mask:0xf bank_mask:0xf
    v_and_b32_dpp v78, v53, v18 row_newbcast:12 row_mask:0xf bank_mask:0xf
    v_and_b32_dpp v79, v53, v19 row_newbcast:12 row_mask:0xf bank_mask:0xf
    v_mfma_f32_16x16x32_bf16 v[80:83], v[72:75], v[196:199], v[80:83]
    buffer_load_dwordx4 v[196:199], v3, s[32:35], s75 offen offset:0 nt
    v_and_b32_dpp v72, v54, v16 row_newbcast:0 row_mask:0xf bank_mask:0xf
    v_and_b32_dpp v73, v54, v17 row_newbcast:0 row_mask:0xf bank_mask:0xf
    v_and_b32_dpp v74, v54, v18 row_newbcast:0 row_mask:0xf bank_mask:0xf
    v_and_b32_dpp v75, v54, v19 row_newbcast:0 row_mask:0xf bank_mask:0xf
    v_mfma_f32_16x16x32_bf16 v[80:83], v[76:79], v[200:203], v[80:83]
    buffer_load_dwordx4 v[200:203], v3, s[32:35], s75 offen offset:1024 nt
    v_and_b32_dpp v76, v54, v16 row_newbcast:4 row_mask:0xf bank_mask:0xf
    v_and_b32_dpp v77, v54, v17 row_newbcast:4 row_mask:0xf bank_mask:0xf
    v_and_b32_dpp v78, v54, v18 row_newbcast:4 row_mask:0xf bank_mask:0xf
    v_and_b32_dpp v79, v54, v19 row_newbcast:4 row_mask:0xf bank_mask:0xf
    v_mfma_f32_16x16x32_bf16 v[80:83], v[72:75], v[172:175], v[80:83]
    buffer_load_dwordx4 v[172:175], v3, s[32:35], s75 offen offset:2048 nt
    v_and_b32_dpp v72, v54, v16 row_newbcast:8 row_mask:0xf bank_mask:0xf
    v_and_b32_dpp v73, v54, v17 row_newbcast:8 row_mask:0xf bank_mask:0xf
    v_and_b32_dpp v74, v54, v18 row_newbcast:8 row_mask:0xf bank_mask:0xf
    v_and_b32_dpp v75, v54, v19 row_newbcast:8 row_mask:0xf bank_mask:0xf
    v_mfma_f32_16x16x32_bf16 v[80:83], v[76:79], v[176:179], v[80:83]
    buffer_load_dwordx4 v[176:179], v3, s[32:35], s75 offen offset:3072 nt
    v_and_b32_dpp v76, v54, v16 row_newbcast:12 row_mask:0xf bank_mask:0xf
    v_and_b32_dpp v77, v54, v17 row_newbcast:12 row_mask:0xf bank_mask:0xf
    v_and_b32_dpp v78, v54, v18 row_newbcast:12 row_mask:0xf bank_mask:0xf
    v_and_b32_dpp v79, v54, v19 row_newbcast:12 row_mask:0xf bank_mask:0xf
    v_mfma_f32_16x16x32_bf16 v[80:83], v[72:75], v[180:183], v[80:83]
    s_mov_b32 s68, 0x30000
    buffer_load_dwordx4 v[180:183], v2, s[28:31], s68 offen offset:0 nt
    v_and_b32_dpp v72, v55, v16 row_newbcast:0 row_mask:0xf bank_mask:0xf
    v_and_b32_dpp v73, v55, v17 row_newbcast:0 row_mask:0xf bank_mask:0xf
    v_and_b32_dpp v74, v55, v18 row_newbcast:0 row_mask:0xf bank_mask:0xf
    v_and_b32_dpp v75, v55, v19 row_newbcast:0 row_mask:0xf bank_mask:0xf
    v_mfma_f32_16x16x32_bf16 v[80:83], v[76:79], v[184:187], v[80:83]
    buffer_load_dwordx4 v[184:187], v2, s[28:31], s68 offen offset:1024 nt
    v_and_b32_dpp v76, v55, v16 row_newbcast:4 row_mask:0xf bank_mask:0xf
    v_and_b32_dpp v77, v55, v17 row_newbcast:4 row_mask:0xf bank_mask:0xf
    v_and_b32_dpp v78, v55, v18 row_newbcast:4 row_mask:0xf bank_mask:0xf
    v_and_b32_dpp v79, v55, v19 row_newbcast:4 row_mask:0xf bank_mask:0xf
    s_waitcnt vmcnt(30)
    v_mfma_f32_16x16x32_bf16 v[80:83], v[72:75], v[140:143], v[80:83]
    buffer_load_dwordx4 v[140:143], v2, s[28:31], s68 offen offset:2048 nt
    v_and_b32_dpp v72, v55, v16 row_newbcast:8 row_mask:0xf bank_mask:0xf
    v_and_b32_dpp v73, v55, v17 row_newbcast:8 row_mask:0xf bank_mask:0xf
    v_and_b32_dpp v74, v55, v18 row_newbcast:8 row_mask:0xf bank_mask:0xf
    v_and_b32_dpp v75, v55, v19 row_newbcast:8 row_mask:0xf bank_mask:0xf
    v_mfma_f32_16x16x32_bf16 v[80:83], v[76:79], v[144:147], v[80:83]
    buffer_load_dwordx4 v[144:147], v2, s[28:31], s68 offen offset:3072 nt
    v_and_b32_dpp v76, v55, v16 row_newbcast:12 row_mask:0xf bank_mask:0xf
    v_and_b32_dpp v77, v55, v17 row_newbcast:12 row_mask:0xf bank_mask:0xf
    v_and_b32_dpp v78, v55, v18 row_newbcast:12 row_mask:0xf bank_mask:0xf
    v_and_b32_dpp v79, v55, v19 row_newbcast:12 row_mask:0xf bank_mask:0xf
    s_waitcnt vmcnt(30)
    v_mfma_f32_16x16x32_bf16 v[80:83], v[72:75], v[148:151], v[80:83]
    buffer_load_dwordx4 v[148:151], v3, s[32:35], s68 offen offset:0 nt
    v_mfma_f32_16x16x32_bf16 v[80:83], v[76:79], v[152:155], v[80:83]
    buffer_load_dwordx4 v[152:155], v3, s[32:35], s68 offen offset:1024 nt
    v_bfe_u32 v90, v1, 3, 1
    v_lshl_add_u32 v90, v85, 1, v90
    v_lshl_add_u32 v90, v90, 2, v88
    ds_read2_b32 v[36:37], v90 offset0:0 offset1:8
    ds_read2_b32 v[38:39], v90 offset0:16 offset1:24
    ds_read2_b32 v[40:41], v90 offset0:32 offset1:40
    ds_read2_b32 v[42:43], v90 offset0:48 offset1:56
    ds_read2_b32 v[44:45], v90 offset0:64 offset1:72
    s_waitcnt lgkmcnt(0)
    v_and_b32 v72, v36, v16
    v_and_b32 v73, v36, v17
    v_and_b32 v74, v36, v18
    v_and_b32 v75, v36, v19
    v_and_b32 v76, v37, v16
    v_and_b32 v77, v37, v17
    v_and_b32 v78, v37, v18
    v_and_b32 v79, v37, v19
    s_waitcnt vmcnt(31)
    v_mfma_f32_16x16x32_bf16 v[48:51], v[72:75], v[92:95], 0
    buffer_load_dwordx4 v[92:95], v3, s[32:35], s68 offen offset:2048 nt
    v_and_b32 v72, v38, v16
    v_and_b32 v73, v38, v17
    v_and_b32 v74, v38, v18
    v_and_b32 v75, v38, v19
    s_waitcnt vmcnt(31)
    v_mfma_f32_16x16x32_bf16 v[48:51], v[76:79], v[96:99], v[48:51]
    buffer_load_dwordx4 v[96:99], v3, s[32:35], s68 offen offset:3072 nt
    v_and_b32 v76, v39, v16
    v_and_b32 v77, v39, v17
    v_and_b32 v78, v39, v18
    v_and_b32 v79, v39, v19
    s_waitcnt vmcnt(31)
    v_mfma_f32_16x16x32_bf16 v[48:51], v[72:75], v[100:103], v[48:51]
    s_mov_b32 s69, 0x38000
    buffer_load_dwordx4 v[100:103], v2, s[28:31], s69 offen offset:0 nt
    v_and_b32 v72, v40, v16
    v_and_b32 v73, v40, v17
    v_and_b32 v74, v40, v18
    v_and_b32 v75, v40, v19
    s_waitcnt vmcnt(31)
    v_mfma_f32_16x16x32_bf16 v[48:51], v[76:79], v[104:107], v[48:51]
    buffer_load_dwordx4 v[104:107], v2, s[28:31], s69 offen offset:1024 nt
    v_and_b32 v76, v41, v16
    v_and_b32 v77, v41, v17
    v_and_b32 v78, v41, v18
    v_and_b32 v79, v41, v19
    s_waitcnt vmcnt(31)
    v_mfma_f32_16x16x32_bf16 v[48:51], v[72:75], v[156:159], v[48:51]
    buffer_load_dwordx4 v[156:159], v2, s[28:31], s69 offen offset:2048 nt
    v_and_b32 v72, v42, v16
    v_and_b32 v73, v42, v17
    v_and_b32 v74, v42, v18
    v_and_b32 v75, v42, v19
    s_waitcnt vmcnt(31)
    v_mfma_f32_16x16x32_bf16 v[48:51], v[76:79], v[160:163], v[48:51]
    buffer_load_dwordx4 v[160:163], v2, s[28:31], s69 offen offset:3072 nt
    v_and_b32 v76, v43, v16
    v_and_b32 v77, v43, v17
    v_and_b32 v78, v43, v18
    v_and_b32 v79, v43, v19
    s_waitcnt vmcnt(31)
    v_mfma_f32_16x16x32_bf16 v[48:51], v[72:75], v[164:167], v[48:51]
    buffer_load_dwordx4 v[164:167], v3, s[32:35], s69 offen offset:0 nt
    v_and_b32 v72, v44, v16
    v_and_b32 v73, v44, v17
    v_and_b32 v74, v44, v18
    v_and_b32 v75, v44, v19
    s_waitcnt vmcnt(31)
    v_mfma_f32_16x16x32_bf16 v[48:51], v[76:79], v[168:171], v[48:51]
    buffer_load_dwordx4 v[168:171], v3, s[32:35], s69 offen offset:1024 nt
    v_and_b32 v76, v45, v16
    v_and_b32 v77, v45, v17
    v_and_b32 v78, v45, v18
    v_and_b32 v79, v45, v19
    s_waitcnt vmcnt(31)
    v_mfma_f32_16x16x32_bf16 v[48:51], v[72:75], v[108:111], v[48:51]
    buffer_load_dwordx4 v[108:111], v3, s[32:35], s69 offen offset:2048 nt
    s_waitcnt vmcnt(31)
    v_mfma_f32_16x16x32_bf16 v[48:51], v[76:79], v[112:115], v[48:51]
    buffer_load_dwordx4 v[112:115], v3, s[32:35], s69 offen offset:3072 nt
    v_bfe_u32 v90, v1, 2, 2
    v_lshl_add_u32 v90, v90, 7, v88
    v_and_b32 v91, 3, v1
    v_lshl_add_u32 v90, v91, 5, v90
    v_and_b32 v91, 1, v85
    v_lshl_add_u32 v90, v91, 4, v90
    s_mov_b32 exec_lo, 0xff00ff
    s_mov_b32 exec_hi, 0xff00ff00
    ds_write_b128 v90, v[48:51] offset:8192
    s_mov_b64 exec, -1
    s_waitcnt vmcnt(28)
    v_mfma_f32_16x16x32_bf16 v[36:39], v[116:119], v[20:23], 0
    v_mfma_f32_16x16x32_bf16 v[36:39], v[120:123], v[24:27], v[36:39]
    v_mfma_f32_16x16x32_bf16 v[36:39], v[204:207], v[28:31], v[36:39]
    v_mfma_f32_16x16x32_bf16 v[36:39], v[208:211], v[32:35], v[36:39]
    buffer_load_dwordx4 v[116:119], v8, s[44:47], 0 offen offset:0
    buffer_load_dwordx4 v[120:123], v8, s[44:47], 0 offen offset:256
    buffer_load_dwordx4 v[204:207], v8, s[44:47], 0 offen offset:512
    buffer_load_dwordx4 v[208:211], v8, s[44:47], 0 offen offset:768
    s_waitcnt vmcnt(24)
    v_mfma_f32_16x16x32_bf16 v[40:43], v[132:135], v[20:23], 0
    v_mfma_f32_16x16x32_bf16 v[40:43], v[136:139], v[24:27], v[40:43]
    v_mfma_f32_16x16x32_bf16 v[40:43], v[188:191], v[28:31], v[40:43]
    v_mfma_f32_16x16x32_bf16 v[40:43], v[192:195], v[32:35], v[40:43]
    buffer_load_dwordx4 v[132:135], v8, s[44:47], 0 offen offset:1024
    s_mov_b32 s70, 0x40000
    buffer_load_dwordx4 v[136:139], v2, s[28:31], s70 offen offset:0 nt
    buffer_load_dwordx4 v[188:191], v2, s[28:31], s70 offen offset:1024 nt
    buffer_load_dwordx4 v[192:195], v2, s[28:31], s70 offen offset:2048 nt
    s_waitcnt vmcnt(20)
    v_mfma_f32_16x16x32_bf16 v[44:47], v[180:183], v[20:23], 0
    v_mfma_f32_16x16x32_bf16 v[44:47], v[184:187], v[24:27], v[44:47]
    v_mfma_f32_16x16x32_bf16 v[44:47], v[140:143], v[28:31], v[44:47]
    v_mfma_f32_16x16x32_bf16 v[44:47], v[144:147], v[32:35], v[44:47]
    buffer_load_dwordx4 v[180:183], v2, s[28:31], s70 offen offset:3072 nt
    s_mov_b32 s71, 0x48000
    buffer_load_dwordx4 v[184:187], v2, s[28:31], s71 offen offset:0 nt
    buffer_load_dwordx4 v[140:143], v2, s[28:31], s71 offen offset:1024 nt
    buffer_load_dwordx4 v[144:147], v2, s[28:31], s71 offen offset:2048 nt
    s_waitcnt vmcnt(16)
    v_mfma_f32_16x16x32_bf16 v[48:51], v[100:103], v[20:23], 0
    v_mfma_f32_16x16x32_bf16 v[48:51], v[104:107], v[24:27], v[48:51]
    v_mfma_f32_16x16x32_bf16 v[48:51], v[156:159], v[28:31], v[48:51]
    v_mfma_f32_16x16x32_bf16 v[48:51], v[160:163], v[32:35], v[48:51]
    buffer_load_dwordx4 v[100:103], v2, s[28:31], s71 offen offset:3072 nt
    s_mov_b32 s72, 0x50000
    buffer_load_dwordx4 v[104:107], v2, s[28:31], s72 offen offset:0 nt
    buffer_load_dwordx4 v[156:159], v2, s[28:31], s72 offen offset:1024 nt
    buffer_load_dwordx4 v[160:163], v2, s[28:31], s72 offen offset:2048 nt
    v_mov_b32_dpp v56, v36 quad_perm:[0,0,0,0] row_mask:0xf bank_mask:0xf
    v_mov_b32_dpp v57, v40 quad_perm:[0,0,0,0] row_mask:0xf bank_mask:0xf
    v_mov_b32_dpp v58, v44 quad_perm:[0,0,0,0] row_mask:0xf bank_mask:0xf
    v_mov_b32_dpp v59, v48 quad_perm:[0,0,0,0] row_mask:0xf bank_mask:0xf
    v_add_f32_dpp v56, v37, v56 quad_perm:[1,1,1,1] row_mask:0xf bank_mask:0xf
    v_add_f32_dpp v57, v41, v57 quad_perm:[1,1,1,1] row_mask:0xf bank_mask:0xf
    v_add_f32_dpp v58, v45, v58 quad_perm:[1,1,1,1] row_mask:0xf bank_mask:0xf
    v_add_f32_dpp v59, v49, v59 quad_perm:[1,1,1,1] row_mask:0xf bank_mask:0xf
    v_add_f32_dpp v56, v38, v56 quad_perm:[2,2,2,2] row_mask:0xf bank_mask:0xf
    v_add_f32_dpp v57, v42, v57 quad_perm:[2,2,2,2] row_mask:0xf bank_mask:0xf
    v_add_f32_dpp v58, v46, v58 quad_perm:[2,2,2,2] row_mask:0xf bank_mask:0xf
    v_add_f32_dpp v59, v50, v59 quad_perm:[2,2,2,2] row_mask:0xf bank_mask:0xf
    v_add_f32_dpp v56, v39, v56 quad_perm:[3,3,3,3] row_mask:0xf bank_mask:0xf
    v_add_f32_dpp v57, v43, v57 quad_perm:[3,3,3,3] row_mask:0xf bank_mask:0xf
    v_add_f32_dpp v58, v47, v58 quad_perm:[3,3,3,3] row_mask:0xf bank_mask:0xf
    v_add_f32_dpp v59, v51, v59 quad_perm:[3,3,3,3] row_mask:0xf bank_mask:0xf
    v_cvt_pk_bf16_f32 v68, v56, v57
    v_cvt_pk_bf16_f32 v69, v58, v59
    v_lshlrev_b32 v56, 16, v68
    v_and_b32 v57, 0xffff0000, v68
    v_lshlrev_b32 v58, 16, v69
    v_and_b32 v59, 0xffff0000, v69
    v_mul_f32 v56, s85, v56
    v_mul_f32 v57, s85, v57
    v_mul_f32 v58, s85, v58
    v_mul_f32 v59, s85, v59
    v_cvt_pk_bf16_f32 v68, v56, v57
    v_cvt_pk_bf16_f32 v69, v58, v59
    v_lshlrev_b32 v56, 16, v68
    v_and_b32 v57, 0xffff0000, v68
    v_lshlrev_b32 v58, 16, v69
    v_and_b32 v59, 0xffff0000, v69
    v_max3_f32 v10, v10, v56, v57
    v_max3_f32 v10, v10, v58, v59
    s_nop 1
    v_max_f32_dpp v10, v10, v10 row_ror:4 row_mask:0xf bank_mask:0xf
    s_nop 1
    v_max_f32_dpp v10, v10, v10 row_ror:8 row_mask:0xf bank_mask:0xf
    v_mov_b32 v36, v10
    s_nop 1
    v_permlane16_swap_b32 v36, v10
    v_max_f32 v10, v36, v10
    v_mov_b32 v36, v10
    s_nop 1
    v_permlane32_swap_b32 v36, v10
    v_max_f32 v10, v36, v10
    v_sub_f32 v37, v9, v10
    v_mul_f32 v37, s84, v37
    v_exp_f32 v37, v37
    v_mov_b32 v9, v10
    v_sub_f32 v56, v56, v10
    v_sub_f32 v57, v57, v10
    v_sub_f32 v58, v58, v10
    v_sub_f32 v59, v59, v10
    v_mul_f32 v56, s84, v56
    v_mul_f32 v57, s84, v57
    v_mul_f32 v58, s84, v58
    v_mul_f32 v59, s84, v59
    v_exp_f32 v56, v56
    v_exp_f32 v57, v57
    v_exp_f32 v58, v58
    v_exp_f32 v59, v59
    v_mul_f32 v11, v11, v37
    v_mul_f32 v80, v80, v37
    v_mul_f32 v81, v81, v37
    v_mul_f32 v82, v82, v37
    v_mul_f32 v83, v83, v37
    v_add_f32 v36, v56, v57
    v_add_f32 v11, v11, v58
    v_add_f32 v36, v36, v59
    v_add_f32 v11, v11, v36
    v_cvt_pk_bf16_f32 v56, v56, v56
    v_cvt_pk_bf16_f32 v57, v57, v57
    v_cvt_pk_bf16_f32 v58, v58, v58
    v_cvt_pk_bf16_f32 v59, v59, v59
    v_and_b32_dpp v72, v56, v16 row_newbcast:0 row_mask:0xf bank_mask:0xf
    v_and_b32_dpp v73, v56, v17 row_newbcast:0 row_mask:0xf bank_mask:0xf
    v_and_b32_dpp v74, v56, v18 row_newbcast:0 row_mask:0xf bank_mask:0xf
    v_and_b32_dpp v75, v56, v19 row_newbcast:0 row_mask:0xf bank_mask:0xf
    v_and_b32_dpp v76, v56, v16 row_newbcast:4 row_mask:0xf bank_mask:0xf
    v_and_b32_dpp v77, v56, v17 row_newbcast:4 row_mask:0xf bank_mask:0xf
    v_and_b32_dpp v78, v56, v18 row_newbcast:4 row_mask:0xf bank_mask:0xf
    v_and_b32_dpp v79, v56, v19 row_newbcast:4 row_mask:0xf bank_mask:0xf
    v_mfma_f32_16x16x32_bf16 v[80:83], v[72:75], v[212:215], v[80:83]
    buffer_load_dwordx4 v[212:215], v2, s[28:31], s72 offen offset:3072 nt
    v_and_b32_dpp v72, v56, v16 row_newbcast:8 row_mask:0xf bank_mask:0xf
    v_and_b32_dpp v73, v56, v17 row_newbcast:8 row_mask:0xf bank_mask:0xf
    v_and_b32_dpp v74, v56, v18 row_newbcast:8 row_mask:0xf bank_mask:0xf
    v_and_b32_dpp v75, v56, v19 row_newbcast:8 row_mask:0xf bank_mask:0xf
    v_mfma_f32_16x16x32_bf16 v[80:83], v[76:79], v[216:219], v[80:83]
    s_mov_b32 s73, 0x58000
    buffer_load_dwordx4 v[216:219], v2, s[28:31], s73 offen offset:0 nt
    v_and_b32_dpp v76, v56, v16 row_newbcast:12 row_mask:0xf bank_mask:0xf
    v_and_b32_dpp v77, v56, v17 row_newbcast:12 row_mask:0xf bank_mask:0xf
    v_and_b32_dpp v78, v56, v18 row_newbcast:12 row_mask:0xf bank_mask:0xf
    v_and_b32_dpp v79, v56, v19 row_newbcast:12 row_mask:0xf bank_mask:0xf
    v_mfma_f32_16x16x32_bf16 v[80:83], v[72:75], v[124:127], v[80:83]
    buffer_load_dwordx4 v[124:127], v2, s[28:31], s73 offen offset:1024 nt
    v_and_b32_dpp v72, v57, v16 row_newbcast:0 row_mask:0xf bank_mask:0xf
    v_and_b32_dpp v73, v57, v17 row_newbcast:0 row_mask:0xf bank_mask:0xf
    v_and_b32_dpp v74, v57, v18 row_newbcast:0 row_mask:0xf bank_mask:0xf
    v_and_b32_dpp v75, v57, v19 row_newbcast:0 row_mask:0xf bank_mask:0xf
    v_mfma_f32_16x16x32_bf16 v[80:83], v[76:79], v[128:131], v[80:83]
    buffer_load_dwordx4 v[128:131], v2, s[28:31], s73 offen offset:2048 nt
    v_and_b32_dpp v76, v57, v16 row_newbcast:4 row_mask:0xf bank_mask:0xf
    v_and_b32_dpp v77, v57, v17 row_newbcast:4 row_mask:0xf bank_mask:0xf
    v_and_b32_dpp v78, v57, v18 row_newbcast:4 row_mask:0xf bank_mask:0xf
    v_and_b32_dpp v79, v57, v19 row_newbcast:4 row_mask:0xf bank_mask:0xf
    v_mfma_f32_16x16x32_bf16 v[80:83], v[72:75], v[196:199], v[80:83]
    buffer_load_dwordx4 v[196:199], v2, s[28:31], s73 offen offset:3072 nt
    v_and_b32_dpp v72, v57, v16 row_newbcast:8 row_mask:0xf bank_mask:0xf
    v_and_b32_dpp v73, v57, v17 row_newbcast:8 row_mask:0xf bank_mask:0xf
    v_and_b32_dpp v74, v57, v18 row_newbcast:8 row_mask:0xf bank_mask:0xf
    v_and_b32_dpp v75, v57, v19 row_newbcast:8 row_mask:0xf bank_mask:0xf
    v_mfma_f32_16x16x32_bf16 v[80:83], v[76:79], v[200:203], v[80:83]
    s_mov_b32 s74, 0x60000
    buffer_load_dwordx4 v[200:203], v2, s[28:31], s74 offen offset:0 nt
    v_and_b32_dpp v76, v57, v16 row_newbcast:12 row_mask:0xf bank_mask:0xf
    v_and_b32_dpp v77, v57, v17 row_newbcast:12 row_mask:0xf bank_mask:0xf
    v_and_b32_dpp v78, v57, v18 row_newbcast:12 row_mask:0xf bank_mask:0xf
    v_and_b32_dpp v79, v57, v19 row_newbcast:12 row_mask:0xf bank_mask:0xf
    v_mfma_f32_16x16x32_bf16 v[80:83], v[72:75], v[172:175], v[80:83]
    buffer_load_dwordx4 v[172:175], v2, s[28:31], s74 offen offset:1024 nt
    v_and_b32_dpp v72, v58, v16 row_newbcast:0 row_mask:0xf bank_mask:0xf
    v_and_b32_dpp v73, v58, v17 row_newbcast:0 row_mask:0xf bank_mask:0xf
    v_and_b32_dpp v74, v58, v18 row_newbcast:0 row_mask:0xf bank_mask:0xf
    v_and_b32_dpp v75, v58, v19 row_newbcast:0 row_mask:0xf bank_mask:0xf
    v_mfma_f32_16x16x32_bf16 v[80:83], v[76:79], v[176:179], v[80:83]
    buffer_load_dwordx4 v[176:179], v2, s[28:31], s74 offen offset:2048 nt
    v_and_b32_dpp v76, v58, v16 row_newbcast:4 row_mask:0xf bank_mask:0xf
    v_and_b32_dpp v77, v58, v17 row_newbcast:4 row_mask:0xf bank_mask:0xf
    v_and_b32_dpp v78, v58, v18 row_newbcast:4 row_mask:0xf bank_mask:0xf
    v_and_b32_dpp v79, v58, v19 row_newbcast:4 row_mask:0xf bank_mask:0xf
    v_mfma_f32_16x16x32_bf16 v[80:83], v[72:75], v[148:151], v[80:83]
    buffer_load_dwordx4 v[148:151], v2, s[28:31], s74 offen offset:3072 nt
    v_and_b32_dpp v72, v58, v16 row_newbcast:8 row_mask:0xf bank_mask:0xf
    v_and_b32_dpp v73, v58, v17 row_newbcast:8 row_mask:0xf bank_mask:0xf
    v_and_b32_dpp v74, v58, v18 row_newbcast:8 row_mask:0xf bank_mask:0xf
    v_and_b32_dpp v75, v58, v19 row_newbcast:8 row_mask:0xf bank_mask:0xf
    v_mfma_f32_16x16x32_bf16 v[80:83], v[76:79], v[152:155], v[80:83]
    s_mov_b32 s75, 0x68000
    buffer_load_dwordx4 v[152:155], v2, s[28:31], s75 offen offset:0 nt
    v_and_b32_dpp v76, v58, v16 row_newbcast:12 row_mask:0xf bank_mask:0xf
    v_and_b32_dpp v77, v58, v17 row_newbcast:12 row_mask:0xf bank_mask:0xf
    v_and_b32_dpp v78, v58, v18 row_newbcast:12 row_mask:0xf bank_mask:0xf
    v_and_b32_dpp v79, v58, v19 row_newbcast:12 row_mask:0xf bank_mask:0xf
    v_mfma_f32_16x16x32_bf16 v[80:83], v[72:75], v[92:95], v[80:83]
    buffer_load_dwordx4 v[92:95], v2, s[28:31], s75 offen offset:1024 nt
    v_and_b32_dpp v72, v59, v16 row_newbcast:0 row_mask:0xf bank_mask:0xf
    v_and_b32_dpp v73, v59, v17 row_newbcast:0 row_mask:0xf bank_mask:0xf
    v_and_b32_dpp v74, v59, v18 row_newbcast:0 row_mask:0xf bank_mask:0xf
    v_and_b32_dpp v75, v59, v19 row_newbcast:0 row_mask:0xf bank_mask:0xf
    v_mfma_f32_16x16x32_bf16 v[80:83], v[76:79], v[96:99], v[80:83]
    buffer_load_dwordx4 v[96:99], v2, s[28:31], s75 offen offset:2048 nt
    v_and_b32_dpp v76, v59, v16 row_newbcast:4 row_mask:0xf bank_mask:0xf
    v_and_b32_dpp v77, v59, v17 row_newbcast:4 row_mask:0xf bank_mask:0xf
    v_and_b32_dpp v78, v59, v18 row_newbcast:4 row_mask:0xf bank_mask:0xf
    v_and_b32_dpp v79, v59, v19 row_newbcast:4 row_mask:0xf bank_mask:0xf
    s_waitcnt vmcnt(30)
    v_mfma_f32_16x16x32_bf16 v[80:83], v[72:75], v[164:167], v[80:83]
    buffer_load_dwordx4 v[164:167], v2, s[28:31], s75 offen offset:3072 nt
    v_and_b32_dpp v72, v59, v16 row_newbcast:8 row_mask:0xf bank_mask:0xf
    v_and_b32_dpp v73, v59, v17 row_newbcast:8 row_mask:0xf bank_mask:0xf
    v_and_b32_dpp v74, v59, v18 row_newbcast:8 row_mask:0xf bank_mask:0xf
    v_and_b32_dpp v75, v59, v19 row_newbcast:8 row_mask:0xf bank_mask:0xf
    v_mfma_f32_16x16x32_bf16 v[80:83], v[76:79], v[168:171], v[80:83]
    s_mov_b32 s68, 0x70000
    buffer_load_dwordx4 v[168:171], v2, s[28:31], s68 offen offset:0 nt
    v_and_b32_dpp v76, v59, v16 row_newbcast:12 row_mask:0xf bank_mask:0xf
    v_and_b32_dpp v77, v59, v17 row_newbcast:12 row_mask:0xf bank_mask:0xf
    v_and_b32_dpp v78, v59, v18 row_newbcast:12 row_mask:0xf bank_mask:0xf
    v_and_b32_dpp v79, v59, v19 row_newbcast:12 row_mask:0xf bank_mask:0xf
    s_waitcnt vmcnt(30)
    v_mfma_f32_16x16x32_bf16 v[80:83], v[72:75], v[108:111], v[80:83]
    buffer_load_dwordx4 v[108:111], v2, s[28:31], s68 offen offset:1024 nt
    v_mfma_f32_16x16x32_bf16 v[80:83], v[76:79], v[112:115], v[80:83]
    buffer_load_dwordx4 v[112:115], v2, s[28:31], s68 offen offset:2048 nt
    s_waitcnt lgkmcnt(0)
    s_barrier
    s_cmp_eq_u32 s56, 5
    s_cbranch_scc0 L_role3
    buffer_load_dword v14, v15, s[92:95], 0 offen sc0 sc1
L_role3:
    v_lshl_add_u32 v90, v84, 2, v85
    v_lshlrev_b32 v90, 2, v90
    v_lshl_add_u32 v90, v86, 8, v90
    v_add_u32 v90, 0x2000, v90
    ds_read2_b32 v[68:69], v90 offset0:0 offset1:32
    s_waitcnt lgkmcnt(0)
    v_add_f32_dpp v68, v68, v68 row_ror:8 row_mask:0xf bank_mask:0xf
    v_add_f32_dpp v69, v69, v69 row_ror:8 row_mask:0xf bank_mask:0xf
    s_nop 0
    v_add_f32_dpp v68, v68, v68 row_ror:4 row_mask:0xf bank_mask:0xf
    v_add_f32_dpp v69, v69, v69 row_ror:4 row_mask:0xf bank_mask:0xf
    s_nop 0
    v_add_f32_dpp v68, v68, v68 row_ror:2 row_mask:0xf bank_mask:0xf
    v_add_f32_dpp v69, v69, v69 row_ror:2 row_mask:0xf bank_mask:0xf
    s_nop 0
    v_add_f32_dpp v68, v68, v68 row_ror:1 row_mask:0xf bank_mask:0xf
    v_add_f32_dpp v69, v69, v69 row_ror:1 row_mask:0xf bank_mask:0xf
    v_cvt_pk_bf16_f32 v70, v68, v69
    v_lshlrev_b32 v68, 16, v70
    v_and_b32 v69, 0xffff0000, v70
    v_mul_f32 v68, v68, v69
    v_cvt_pk_bf16_f32 v70, v68, v68
    v_and_b32 v72, v70, v16
    v_and_b32 v73, v70, v17
    v_and_b32 v74, v70, v18
    v_and_b32 v75, v70, v19
    s_waitcnt vmcnt(31)
    s_nop 0
    v_mfma_f32_16x16x32_bf16 v[36:39], v[72:75], v[116:119], 0
    buffer_load_dwordx4 v[116:119], v2, s[28:31], s68 offen offset:3072 nt
    s_waitcnt vmcnt(31)
    v_mfma_f32_16x16x32_bf16 v[40:43], v[72:75], v[120:123], 0
    s_mov_b32 s69, 0x78000
    buffer_load_dwordx4 v[120:123], v2, s[28:31], s69 offen offset:0 nt
    s_waitcnt vmcnt(31)
    v_mfma_f32_16x16x32_bf16 v[44:47], v[72:75], v[204:207], 0
    buffer_load_dwordx4 v[204:207], v2, s[28:31], s69 offen offset:1024 nt
    s_waitcnt vmcnt(31)
    v_mfma_f32_16x16x32_bf16 v[48:51], v[72:75], v[208:211], 0
    buffer_load_dwordx4 v[208:211], v2, s[28:31], s69 offen offset:2048 nt
    s_waitcnt vmcnt(31)
    v_mfma_f32_16x16x32_bf16 v[76:79], v[72:75], v[132:135], 0
    buffer_load_dwordx4 v[132:135], v2, s[28:31], s69 offen offset:3072 nt
    s_mul_i32 s62, s56, 2560
    v_add_u32 v90, s62, v87
    s_mov_b32 exec_lo, 0xffffffff
    s_mov_b32 exec_hi, 0x0
    ds_write_b128 v90, v[36:39] offset:16896
    ds_write_b128 v90, v[40:43] offset:17408
    ds_write_b128 v90, v[44:47] offset:17920
    ds_write_b128 v90, v[48:51] offset:18432
    ds_write_b128 v90, v[76:79] offset:18944
    s_mov_b64 exec, -1
    s_waitcnt vmcnt(28)
    v_mfma_f32_16x16x32_bf16 v[36:39], v[136:139], v[20:23], 0
    v_mfma_f32_16x16x32_bf16 v[36:39], v[188:191], v[24:27], v[36:39]
    v_mfma_f32_16x16x32_bf16 v[36:39], v[192:195], v[28:31], v[36:39]
    v_mfma_f32_16x16x32_bf16 v[36:39], v[180:183], v[32:35], v[36:39]
    buffer_load_dwordx4 v[136:139], v3, s[32:35], s70 offen offset:0 nt
    buffer_load_dwordx4 v[188:191], v3, s[32:35], s70 offen offset:1024 nt
    buffer_load_dwordx4 v[192:195], v3, s[32:35], s70 offen offset:2048 nt
    buffer_load_dwordx4 v[180:183], v3, s[32:35], s70 offen offset:3072 nt
    s_waitcnt vmcnt(28)
    v_mfma_f32_16x16x32_bf16 v[40:43], v[184:187], v[20:23], 0
    v_mfma_f32_16x16x32_bf16 v[40:43], v[140:143], v[24:27], v[40:43]
    v_mfma_f32_16x16x32_bf16 v[40:43], v[144:147], v[28:31], v[40:43]
    v_mfma_f32_16x16x32_bf16 v[40:43], v[100:103], v[32:35], v[40:43]
    buffer_load_dwordx4 v[184:187], v3, s[32:35], s71 offen offset:0 nt
    buffer_load_dwordx4 v[140:143], v3, s[32:35], s71 offen offset:1024 nt
    buffer_load_dwordx4 v[144:147], v3, s[32:35], s71 offen offset:2048 nt
    buffer_load_dwordx4 v[100:103], v3, s[32:35], s71 offen offset:3072 nt
    s_waitcnt vmcnt(28)
    v_mfma_f32_16x16x32_bf16 v[44:47], v[104:107], v[20:23], 0
    v_mfma_f32_16x16x32_bf16 v[44:47], v[156:159], v[24:27], v[44:47]
    v_mfma_f32_16x16x32_bf16 v[44:47], v[160:163], v[28:31], v[44:47]
    v_mfma_f32_16x16x32_bf16 v[44:47], v[212:215], v[32:35], v[44:47]
    buffer_load_dwordx4 v[104:107], v3, s[32:35], s72 offen offset:0 nt
    buffer_load_dwordx4 v[156:159], v3, s[32:35], s72 offen offset:1024 nt
    buffer_load_dwordx4 v[160:163], v3, s[32:35], s72 offen offset:2048 nt
    buffer_load_dwordx4 v[212:215], v3, s[32:35], s72 offen offset:3072 nt
    s_waitcnt vmcnt(28)
    v_mfma_f32_16x16x32_bf16 v[48:51], v[216:219], v[20:23], 0
    v_mfma_f32_16x16x32_bf16 v[48:51], v[124:127], v[24:27], v[48:51]
    v_mfma_f32_16x16x32_bf16 v[48:51], v[128:131], v[28:31], v[48:51]
    v_mfma_f32_16x16x32_bf16 v[48:51], v[196:199], v[32:35], v[48:51]
    buffer_load_dwordx4 v[216:219], v7, s[40:43], 0 offen offset:0
    buffer_load_dwordx4 v[124:127], v7, s[40:43], 0 offen offset:256
    buffer_load_dwordx4 v[128:131], v7, s[40:43], 0 offen offset:512
    buffer_load_dwordx4 v[196:199], v7, s[40:43], 0 offen offset:768
    v_mov_b32_dpp v60, v36 quad_perm:[0,0,0,0] row_mask:0xf bank_mask:0xf
    v_mov_b32_dpp v61, v40 quad_perm:[0,0,0,0] row_mask:0xf bank_mask:0xf
    v_mov_b32_dpp v62, v44 quad_perm:[0,0,0,0] row_mask:0xf bank_mask:0xf
    s_nop 0
    v_mov_b32_dpp v63, v48 quad_perm:[0,0,0,0] row_mask:0xf bank_mask:0xf
    v_add_f32_dpp v60, v37, v60 quad_perm:[1,1,1,1] row_mask:0xf bank_mask:0xf
    v_add_f32_dpp v61, v41, v61 quad_perm:[1,1,1,1] row_mask:0xf bank_mask:0xf
    v_add_f32_dpp v62, v45, v62 quad_perm:[1,1,1,1] row_mask:0xf bank_mask:0xf
    v_add_f32_dpp v63, v49, v63 quad_perm:[1,1,1,1] row_mask:0xf bank_mask:0xf
    v_add_f32_dpp v60, v38, v60 quad_perm:[2,2,2,2] row_mask:0xf bank_mask:0xf
    v_add_f32_dpp v61, v42, v61 quad_perm:[2,2,2,2] row_mask:0xf bank_mask:0xf
    v_add_f32_dpp v62, v46, v62 quad_perm:[2,2,2,2] row_mask:0xf bank_mask:0xf
    v_add_f32_dpp v63, v50, v63 quad_perm:[2,2,2,2] row_mask:0xf bank_mask:0xf
    v_add_f32_dpp v60, v39, v60 quad_perm:[3,3,3,3] row_mask:0xf bank_mask:0xf
    v_add_f32_dpp v61, v43, v61 quad_perm:[3,3,3,3] row_mask:0xf bank_mask:0xf
    v_add_f32_dpp v62, v47, v62 quad_perm:[3,3,3,3] row_mask:0xf bank_mask:0xf
    v_add_f32_dpp v63, v51, v63 quad_perm:[3,3,3,3] row_mask:0xf bank_mask:0xf
    v_cvt_pk_bf16_f32 v68, v60, v61
    v_cvt_pk_bf16_f32 v69, v62, v63
    v_lshlrev_b32 v60, 16, v68
    v_and_b32 v61, 0xffff0000, v68
    v_lshlrev_b32 v62, 16, v69
    v_and_b32 v63, 0xffff0000, v69
    v_mul_f32 v60, s85, v60
    v_mul_f32 v61, s85, v61
    v_mul_f32 v62, s85, v62
    v_mul_f32 v63, s85, v63
    v_cvt_pk_bf16_f32 v68, v60, v61
    v_cvt_pk_bf16_f32 v69, v62, v63
    v_lshlrev_b32 v60, 16, v68
    v_and_b32 v61, 0xffff0000, v68
    v_lshlrev_b32 v62, 16, v69
    v_and_b32 v63, 0xffff0000, v69
    v_max3_f32 v10, v10, v60, v61
    v_max3_f32 v10, v10, v62, v63
    s_waitcnt vmcnt(28)
    v_mfma_f32_16x16x32_bf16 v[36:39], v[200:203], v[20:23], 0
    v_mfma_f32_16x16x32_bf16 v[36:39], v[172:175], v[24:27], v[36:39]
    v_mfma_f32_16x16x32_bf16 v[36:39], v[176:179], v[28:31], v[36:39]
    v_mfma_f32_16x16x32_bf16 v[36:39], v[148:151], v[32:35], v[36:39]
    buffer_load_dwordx4 v[200:203], v7, s[40:43], 0 offen offset:1024
    s_mov_b32 s70, 0x1400
    buffer_load_dwordx4 v[172:175], v7, s[40:43], s70 offen offset:0
    buffer_load_dwordx4 v[176:179], v7, s[40:43], s70 offen offset:256
    buffer_load_dwordx4 v[148:151], v7, s[40:43], s70 offen offset:512
    s_waitcnt vmcnt(28)
    v_mfma_f32_16x16x32_bf16 v[40:43], v[152:155], v[20:23], 0
    v_mfma_f32_16x16x32_bf16 v[40:43], v[92:95], v[24:27], v[40:43]
    v_mfma_f32_16x16x32_bf16 v[40:43], v[96:99], v[28:31], v[40:43]
    v_mfma_f32_16x16x32_bf16 v[40:43], v[164:167], v[32:35], v[40:43]
    buffer_load_dwordx4 v[152:155], v7, s[40:43], s70 offen offset:768
    buffer_load_dwordx4 v[92:95], v7, s[40:43], s70 offen offset:1024
    s_mov_b32 s71, 0x2800
    buffer_load_dwordx4 v[96:99], v7, s[40:43], s71 offen offset:0
    buffer_load_dwordx4 v[164:167], v7, s[40:43], s71 offen offset:256
    s_waitcnt vmcnt(28)
    v_mfma_f32_16x16x32_bf16 v[44:47], v[168:171], v[20:23], 0
    v_mfma_f32_16x16x32_bf16 v[44:47], v[108:111], v[24:27], v[44:47]
    v_mfma_f32_16x16x32_bf16 v[44:47], v[112:115], v[28:31], v[44:47]
    v_mfma_f32_16x16x32_bf16 v[44:47], v[116:119], v[32:35], v[44:47]
    buffer_load_dwordx4 v[168:171], v7, s[40:43], s71 offen offset:512
    buffer_load_dwordx4 v[108:111], v7, s[40:43], s71 offen offset:768
    buffer_load_dwordx4 v[112:115], v7, s[40:43], s71 offen offset:1024
    s_mov_b32 s72, 0x3c00
    buffer_load_dwordx4 v[116:119], v7, s[40:43], s72 offen offset:0
    s_waitcnt vmcnt(28)
    v_mfma_f32_16x16x32_bf16 v[48:51], v[120:123], v[20:23], 0
    v_mfma_f32_16x16x32_bf16 v[48:51], v[204:207], v[24:27], v[48:51]
    v_mfma_f32_16x16x32_bf16 v[48:51], v[208:211], v[28:31], v[48:51]
    v_mfma_f32_16x16x32_bf16 v[48:51], v[132:135], v[32:35], v[48:51]
    buffer_load_dwordx4 v[120:123], v7, s[40:43], s72 offen offset:256
    buffer_load_dwordx4 v[204:207], v7, s[40:43], s72 offen offset:512
    buffer_load_dwordx4 v[208:211], v7, s[40:43], s72 offen offset:768
    buffer_load_dwordx4 v[132:135], v7, s[40:43], s72 offen offset:1024
    v_mov_b32_dpp v64, v36 quad_perm:[0,0,0,0] row_mask:0xf bank_mask:0xf
    v_mov_b32_dpp v65, v40 quad_perm:[0,0,0,0] row_mask:0xf bank_mask:0xf
    v_mov_b32_dpp v66, v44 quad_perm:[0,0,0,0] row_mask:0xf bank_mask:0xf
    s_nop 0
    v_mov_b32_dpp v67, v48 quad_perm:[0,0,0,0] row_mask:0xf bank_mask:0xf
    v_add_f32_dpp v64, v37, v64 quad_perm:[1,1,1,1] row_mask:0xf bank_mask:0xf
    v_add_f32_dpp v65, v41, v65 quad_perm:[1,1,1,1] row_mask:0xf bank_mask:0xf
    v_add_f32_dpp v66, v45, v66 quad_perm:[1,1,1,1] row_mask:0xf bank_mask:0xf
    v_add_f32_dpp v67, v49, v67 quad_perm:[1,1,1,1] row_mask:0xf bank_mask:0xf
    v_add_f32_dpp v64, v38, v64 quad_perm:[2,2,2,2] row_mask:0xf bank_mask:0xf
    v_add_f32_dpp v65, v42, v65 quad_perm:[2,2,2,2] row_mask:0xf bank_mask:0xf
    v_add_f32_dpp v66, v46, v66 quad_perm:[2,2,2,2] row_mask:0xf bank_mask:0xf
    v_add_f32_dpp v67, v50, v67 quad_perm:[2,2,2,2] row_mask:0xf bank_mask:0xf
    v_add_f32_dpp v64, v39, v64 quad_perm:[3,3,3,3] row_mask:0xf bank_mask:0xf
    v_add_f32_dpp v65, v43, v65 quad_perm:[3,3,3,3] row_mask:0xf bank_mask:0xf
    v_add_f32_dpp v66, v47, v66 quad_perm:[3,3,3,3] row_mask:0xf bank_mask:0xf
    v_add_f32_dpp v67, v51, v67 quad_perm:[3,3,3,3] row_mask:0xf bank_mask:0xf
    v_cvt_pk_bf16_f32 v68, v64, v65
    v_cvt_pk_bf16_f32 v69, v66, v67
    v_lshlrev_b32 v64, 16, v68
    v_and_b32 v65, 0xffff0000, v68
    v_lshlrev_b32 v66, 16, v69
    v_and_b32 v67, 0xffff0000, v69
    v_mul_f32 v64, s85, v64
    v_mul_f32 v65, s85, v65
    v_mul_f32 v66, s85, v66
    v_mul_f32 v67, s85, v67
    v_cvt_pk_bf16_f32 v68, v64, v65
    v_cvt_pk_bf16_f32 v69, v66, v67
    v_lshlrev_b32 v64, 16, v68
    v_and_b32 v65, 0xffff0000, v68
    v_lshlrev_b32 v66, 16, v69
    v_and_b32 v67, 0xffff0000, v69
    v_max3_f32 v10, v10, v64, v65
    v_max3_f32 v10, v10, v66, v67
    s_nop 1
    v_max_f32_dpp v10, v10, v10 row_ror:4 row_mask:0xf bank_mask:0xf
    s_nop 1
    v_max_f32_dpp v10, v10, v10 row_ror:8 row_mask:0xf bank_mask:0xf
    v_mov_b32 v36, v10
    s_nop 1
    v_permlane16_swap_b32 v36, v10
    v_max_f32 v10, v36, v10
    v_mov_b32 v36, v10
    s_nop 1
    v_permlane32_swap_b32 v36, v10
    v_max_f32 v10, v36, v10
    v_sub_f32 v37, v9, v10
    v_mul_f32 v37, s84, v37
    v_exp_f32 v37, v37
    v_mov_b32 v9, v10
    v_sub_f32 v60, v60, v10
    v_sub_f32 v61, v61, v10
    v_sub_f32 v62, v62, v10
    v_sub_f32 v63, v63, v10
    v_sub_f32 v64, v64, v10
    v_sub_f32 v65, v65, v10
    v_sub_f32 v66, v66, v10
    v_sub_f32 v67, v67, v10
    v_mul_f32 v60, s84, v60
    v_mul_f32 v61, s84, v61
    v_mul_f32 v62, s84, v62
    v_mul_f32 v63, s84, v63
    v_mul_f32 v64, s84, v64
    v_mul_f32 v65, s84, v65
    v_mul_f32 v66, s84, v66
    v_mul_f32 v67, s84, v67
    v_exp_f32 v60, v60
    v_exp_f32 v61, v61
    v_exp_f32 v62, v62
    v_exp_f32 v63, v63
    v_exp_f32 v64, v64
    v_exp_f32 v65, v65
    v_exp_f32 v66, v66
    v_exp_f32 v67, v67
    v_mul_f32 v11, v11, v37
    v_mul_f32 v80, v80, v37
    v_mul_f32 v81, v81, v37
    v_mul_f32 v82, v82, v37
    v_mul_f32 v83, v83, v37
    v_add_f32 v36, v60, v61
    v_add_f32 v11, v11, v62
    v_add_f32 v36, v36, v63
    v_add_f32 v11, v11, v64
    v_add_f32 v36, v36, v65
    v_add_f32 v11, v11, v66
    v_add_f32 v36, v36, v67
    v_add_f32 v11, v11, v36
    v_cvt_pk_bf16_f32 v60, v60, v60
    v_cvt_pk_bf16_f32 v61, v61, v61
    v_cvt_pk_bf16_f32 v62, v62, v62
    v_cvt_pk_bf16_f32 v63, v63, v63
    v_cvt_pk_bf16_f32 v64, v64, v64
    v_cvt_pk_bf16_f32 v65, v65, v65
    v_cvt_pk_bf16_f32 v66, v66, v66
    v_cvt_pk_bf16_f32 v67, v67, v67
    v_add_f32_dpp v11, v11, v11 row_ror:4 row_mask:0xf bank_mask:0xf
    s_nop 1
    v_add_f32_dpp v11, v11, v11 row_ror:8 row_mask:0xf bank_mask:0xf
    v_mov_b32 v36, v11
    s_nop 1
    v_permlane16_swap_b32 v36, v11
    v_add_f32 v11, v36, v11
    v_mov_b32 v36, v11
    s_nop 1
    v_permlane32_swap_b32 v36, v11
    v_add_f32 v11, v36, v11
    v_lshlrev_b32 v91, 3, v84
    s_mov_b32 exec_lo, 0x1
    s_mov_b32 exec_hi, 0x0
    ds_write_b64 v91, v[10:11] offset:16384
    s_mov_b64 exec, -1
    s_cmp_eq_u32 s56, 5
    s_cbranch_scc0 L_role4
    s_waitcnt vmcnt(37)
    s_mov_b32 s89, 0x100000
L_spin5:
    v_readfirstlane_b32 s65, v14
    s_nop 2
    s_cmp_ge_u32 s65, 8
    s_cbranch_scc1 L_spun5
    s_sub_u32 s89, s89, 1
    s_cmp_eq_u32 s89, 0
    s_cbranch_scc1 L_spun5
    s_sleep 8
    buffer_load_dword v14, v15, s[92:95], 0 offen sc0 sc1
    s_waitcnt vmcnt(0)
    s_branch L_spin5
L_spun5:
L_role4:
    v_mov_b32 v91, 0
    s_waitcnt lgkmcnt(0)
    s_barrier
    ds_read_b128 v[20:23], v91 offset:16384
    ds_read_b128 v[24:27], v91 offset:16400
    ds_read_b128 v[28:31], v91 offset:16416
    ds_read_b128 v[32:35], v91 offset:16432
    s_waitcnt lgkmcnt(0)
    v_max3_f32 v36, v20, v22, v24
    v_max3_f32 v36, v36, v26, v28
    v_max3_f32 v36, v36, v30, v32
    v_max_f32 v36, v36, v34
    v_sub_f32 v9, v10, v36
    v_sub_f32 v20, v20, v36
    v_sub_f32 v22, v22, v36
    v_sub_f32 v24, v24, v36
    v_sub_f32 v26, v26, v36
    v_sub_f32 v28, v28, v36
    v_sub_f32 v30, v30, v36
    v_sub_f32 v32, v32, v36
    v_sub_f32 v34, v34, v36
    v_mul_f32 v9, s84, v9
    v_mul_f32 v20, s84, v20
    v_mul_f32 v22, s84, v22
    v_mul_f32 v24, s84, v24
    v_mul_f32 v26, s84, v26
    v_mul_f32 v28, s84, v28
    v_mul_f32 v30, s84, v30
    v_mul_f32 v32, s84, v32
    v_mul_f32 v34, s84, v34
    v_exp_f32 v9, v9
    v_exp_f32 v20, v20
    v_exp_f32 v22, v22
    v_exp_f32 v24, v24
    v_exp_f32 v26, v26
    v_exp_f32 v28, v28
    v_exp_f32 v30, v30
    v_exp_f32 v32, v32
    v_exp_f32 v34, v34
    v_mov_b32 v10, v36
    v_mul_f32 v11, v20, v21
    v_fmac_f32 v11, v22, v23
    v_fmac_f32 v11, v24, v25
    v_fmac_f32 v11, v26, v27
    v_fmac_f32 v11, v28, v29
    v_fmac_f32 v11, v30, v31
    v_fmac_f32 v11, v32, v33
    v_fmac_f32 v11, v34, v35
    s_cmp_eq_u32 s56, 5
    s_cbranch_scc0 L_role6
    s_lshr_b32 s62, s88, 1
    s_lshl_b32 s62, s62, 7
    s_lshl_b32 s63, s59, 3
    s_add_u32 s62, s62, s63
    s_add_u32 s62, s62, 0x8000
    v_mov_b32 v14, s62
    s_xor_b32 s62, s62, 8
    v_mov_b32 v12, s62
    s_mov_b32 exec_lo, 0x1
    s_mov_b32 exec_hi, 0x0
    buffer_store_dwordx2 v[10:11], v14, s[52:55], 0 offen sc0 sc1
    s_mov_b64 exec, -1
L_role6:
    s_cmp_lt_u32 s56, 5
    s_cbranch_scc0 L_role7
    s_cmp_ge_u32 s60, 54
    s_cbranch_scc1 L_noyf
    v_lshl_add_u32 v90, v1, 2, v88
    s_mul_i32 s62, s58, 2560
    s_add_u32 s62, s62, 0x1000
    v_add_u32 v91, s62, v90
    v_add_u32 v90, 0x4200, v90
    ds_read2st64_b32 v[36:37], v90 offset0:0 offset1:1
    ds_read2st64_b32 v[38:39], v90 offset0:10 offset1:11
    ds_read2st64_b32 v[40:41], v90 offset0:20 offset1:21
    ds_read2st64_b32 v[42:43], v90 offset0:30 offset1:31
    ds_read2st64_b32 v[44:45], v90 offset0:40 offset1:41
    ds_read2st64_b32 v[46:47], v90 offset0:50 offset1:51
    ds_read2st64_b32 v[48:49], v90 offset0:60 offset1:61
    ds_read2st64_b32 v[50:51], v90 offset0:70 offset1:71
    s_waitcnt lgkmcnt(6)
    v_add_f32 v36, v36, v38
    v_add_f32 v37, v37, v39
    s_waitcnt lgkmcnt(5)
    v_add_f32 v36, v36, v40
    v_add_f32 v37, v37, v41
    s_waitcnt lgkmcnt(4)
    v_add_f32 v36, v36, v42
    v_add_f32 v37, v37, v43
    s_waitcnt lgkmcnt(3)
    v_add_f32 v36, v36, v44
    v_add_f32 v37, v37, v45
    s_waitcnt lgkmcnt(2)
    v_add_f32 v36, v36, v46
    v_add_f32 v37, v37, v47
    s_waitcnt lgkmcnt(1)
    v_add_f32 v36, v36, v48
    v_add_f32 v37, v37, v49
    s_waitcnt lgkmcnt(0)
    v_add_f32 v36, v36, v50
    v_add_f32 v37, v37, v51
    s_movk_i32 s63, 0x2800
    buffer_atomic_add_f32 v36, v91, s[52:55], s63 offen sc1
    buffer_atomic_add_f32 v37, v91, s[52:55], s63 offen offset:256 sc1
L_noyf:
    s_waitcnt lgkmcnt(0)
L_role7:
    v_and_b32_dpp v72, v60, v16 row_newbcast:0 row_mask:0xf bank_mask:0xf
    v_and_b32_dpp v73, v60, v17 row_newbcast:0 row_mask:0xf bank_mask:0xf
    v_and_b32_dpp v74, v60, v18 row_newbcast:0 row_mask:0xf bank_mask:0xf
    v_and_b32_dpp v75, v60, v19 row_newbcast:0 row_mask:0xf bank_mask:0xf
    v_and_b32_dpp v76, v60, v16 row_newbcast:4 row_mask:0xf bank_mask:0xf
    v_and_b32_dpp v77, v60, v17 row_newbcast:4 row_mask:0xf bank_mask:0xf
    v_and_b32_dpp v78, v60, v18 row_newbcast:4 row_mask:0xf bank_mask:0xf
    v_and_b32_dpp v79, v60, v19 row_newbcast:4 row_mask:0xf bank_mask:0xf
    s_waitcnt vmcnt(30)
    v_mfma_f32_16x16x32_bf16 v[80:83], v[72:75], v[136:139], v[80:83]
    buffer_load_dwordx4 v[136:139], v3, s[32:35], s73 offen offset:0 nt
    v_and_b32_dpp v72, v60, v16 row_newbcast:8 row_mask:0xf bank_mask:0xf
    v_and_b32_dpp v73, v60, v17 row_newbcast:8 row_mask:0xf bank_mask:0xf
    v_and_b32_dpp v74, v60, v18 row_newbcast:8 row_mask:0xf bank_mask:0xf
    v_and_b32_dpp v75, v60, v19 row_newbcast:8 row_mask:0xf bank_mask:0xf
    v_mfma_f32_16x16x32_bf16 v[80:83], v[76:79], v[188:191], v[80:83]
    buffer_load_dwordx4 v[188:191], v3, s[32:35], s73 offen offset:1024 nt
    v_and_b32_dpp v76, v60, v16 row_newbcast:12 row_mask:0xf bank_mask:0xf
    v_and_b32_dpp v77, v60, v17 row_newbcast:12 row_mask:0xf bank_mask:0xf
    v_and_b32_dpp v78, v60, v18 row_newbcast:12 row_mask:0xf bank_mask:0xf
    v_and_b32_dpp v79, v60, v19 row_newbcast:12 row_mask:0xf bank_mask:0xf
    s_waitcnt vmcnt(30)
    v_mfma_f32_16x16x32_bf16 v[80:83], v[72:75], v[192:195], v[80:83]
    buffer_load_dwordx4 v[192:195], v3, s[32:35], s73 offen offset:2048 nt
    v_and_b32_dpp v72, v61, v16 row_newbcast:0 row_mask:0xf bank_mask:0xf
    v_and_b32_dpp v73, v61, v17 row_newbcast:0 row_mask:0xf bank_mask:0xf
    v_and_b32_dpp v74, v61, v18 row_newbcast:0 row_mask:0xf bank_mask:0xf
    v_and_b32_dpp v75, v61, v19 row_newbcast:0 row_mask:0xf bank_mask:0xf
    v_mfma_f32_16x16x32_bf16 v[80:83], v[76:79], v[180:183], v[80:83]
    buffer_load_dwordx4 v[180:183], v3, s[32:35], s73 offen offset:3072 nt
    v_and_b32_dpp v76, v61, v16 row_newbcast:4 row_mask:0xf bank_mask:0xf
    v_and_b32_dpp v77, v61, v17 row_newbcast:4 row_mask:0xf bank_mask:0xf
    v_and_b32_dpp v78, v61, v18 row_newbcast:4 row_mask:0xf bank_mask:0xf
    v_and_b32_dpp v79, v61, v19 row_newbcast:4 row_mask:0xf bank_mask:0xf
    s_waitcnt vmcnt(30)
    v_mfma_f32_16x16x32_bf16 v[80:83], v[72:75], v[184:187], v[80:83]
    buffer_load_dwordx4 v[184:187], v3, s[32:35], s74 offen offset:0 nt
    v_and_b32_dpp v72, v61, v16 row_newbcast:8 row_mask:0xf bank_mask:0xf
    v_and_b32_dpp v73, v61, v17 row_newbcast:8 row_mask:0xf bank_mask:0xf
    v_and_b32_dpp v74, v61, v18 row_newbcast:8 row_mask:0xf bank_mask:0xf
    v_and_b32_dpp v75, v61, v19 row_newbcast:8 row_mask:0xf bank_mask:0xf
    v_mfma_f32_16x16x32_bf16 v[80:83], v[76:79], v[140:143], v[80:83]
    buffer_load_dwordx4 v[140:143], v3, s[32:35], s74 offen offset:1024 nt
    v_and_b32_dpp v76, v61, v16 row_newbcast:12 row_mask:0xf bank_mask:0xf
    v_and_b32_dpp v77, v61, v17 row_newbcast:12 row_mask:0xf bank_mask:0xf
    v_and_b32_dpp v78, v61, v18 row_newbcast:12 row_mask:0xf bank_mask:0xf
    v_and_b32_dpp v79, v61, v19 row_newbcast:12 row_mask:0xf bank_mask:0xf
    s_waitcnt vmcnt(30)
    v_mfma_f32_16x16x32_bf16 v[80:83], v[72:75], v[144:147], v[80:83]
    buffer_load_dwordx4 v[144:147], v3, s[32:35], s74 offen offset:2048 nt
    v_and_b32_dpp v72, v62, v16 row_newbcast:0 row_mask:0xf bank_mask:0xf
    v_and_b32_dpp v73, v62, v17 row_newbcast:0 row_mask:0xf bank_mask:0xf
    v_and_b32_dpp v74, v62, v18 row_newbcast:0 row_mask:0xf bank_mask:0xf
    v_and_b32_dpp v75, v62, v19 row_newbcast:0 row_mask:0xf bank_mask:0xf
    v_mfma_f32_16x16x32_bf16 v[80:83], v[76:79], v[100:103], v[80:83]
    buffer_load_dwordx4 v[100:103], v3, s[32:35], s74 offen offset:3072 nt
    v_and_b32_dpp v76, v62, v16 row_newbcast:4 row_mask:0xf bank_mask:0xf
    v_and_b32_dpp v77, v62, v17 row_newbcast:4 row_mask:0xf bank_mask:0xf
    v_and_b32_dpp v78, v62, v18 row_newbcast:4 row_mask:0xf bank_mask:0xf
    v_and_b32_dpp v79, v62, v19 row_newbcast:4 row_mask:0xf bank_mask:0xf
    s_waitcnt vmcnt(30)
    v_mfma_f32_16x16x32_bf16 v[80:83], v[72:75], v[104:107], v[80:83]
    buffer_load_dwordx4 v[104:107], v3, s[32:35], s75 offen offset:0 nt
    v_and_b32_dpp v72, v62, v16 row_newbcast:8 row_mask:0xf bank_mask:0xf
    v_and_b32_dpp v73, v62, v17 row_newbcast:8 row_mask:0xf bank_mask:0xf
    v_and_b32_dpp v74, v62, v18 row_newbcast:8 row_mask:0xf bank_mask:0xf
    v_and_b32_dpp v75, v62, v19 row_newbcast:8 row_mask:0xf bank_mask:0xf
    v_mfma_f32_16x16x32_bf16 v[80:83], v[76:79], v[156:159], v[80:83]
    buffer_load_dwordx4 v[156:159], v3, s[32:35], s75 offen offset:1024 nt
    v_and_b32_dpp v76, v62, v16 row_newbcast:12 row_mask:0xf bank_mask:0xf
    v_and_b32_dpp v77, v62, v17 row_newbcast:12 row_mask:0xf bank_mask:0xf
    v_and_b32_dpp v78, v62, v18 row_newbcast:12 row_mask:0xf bank_mask:0xf
    v_and_b32_dpp v79, v62, v19 row_newbcast:12 row_mask:0xf bank_mask:0xf
    s_waitcnt vmcnt(30)
    v_mfma_f32_16x16x32_bf16 v[80:83], v[72:75], v[160:163], v[80:83]
    buffer_load_dwordx4 v[160:163], v3, s[32:35], s75 offen offset:2048 nt
    v_and_b32_dpp v72, v63, v16 row_newbcast:0 row_mask:0xf bank_mask:0xf
    v_and_b32_dpp v73, v63, v17 row_newbcast:0 row_mask:0xf bank_mask:0xf
    v_and_b32_dpp v74, v63, v18 row_newbcast:0 row_mask:0xf bank_mask:0xf
    v_and_b32_dpp v75, v63, v19 row_newbcast:0 row_mask:0xf bank_mask:0xf
    v_mfma_f32_16x16x32_bf16 v[80:83], v[76:79], v[212:215], v[80:83]
    buffer_load_dwordx4 v[212:215], v3, s[32:35], s75 offen offset:3072 nt
    v_and_b32_dpp v76, v63, v16 row_newbcast:4 row_mask:0xf bank_mask:0xf
    v_and_b32_dpp v77, v63, v17 row_newbcast:4 row_mask:0xf bank_mask:0xf
    v_and_b32_dpp v78, v63, v18 row_newbcast:4 row_mask:0xf bank_mask:0xf
    v_and_b32_dpp v79, v63, v19 row_newbcast:4 row_mask:0xf bank_mask:0xf
    s_waitcnt vmcnt(10)
    v_mfma_f32_16x16x32_bf16 v[80:83], v[72:75], v[136:139], v[80:83]
    buffer_load_dwordx4 v[136:139], v3, s[32:35], s68 offen offset:0 nt
    v_and_b32_dpp v72, v63, v16 row_newbcast:8 row_mask:0xf bank_mask:0xf
    v_and_b32_dpp v73, v63, v17 row_newbcast:8 row_mask:0xf bank_mask:0xf
    v_and_b32_dpp v74, v63, v18 row_newbcast:8 row_mask:0xf bank_mask:0xf
    v_and_b32_dpp v75, v63, v19 row_newbcast:8 row_mask:0xf bank_mask:0xf
    v_mfma_f32_16x16x32_bf16 v[80:83], v[76:79], v[188:191], v[80:83]
    buffer_load_dwordx4 v[188:191], v3, s[32:35], s68 offen offset:1024 nt
    v_and_b32_dpp v76, v63, v16 row_newbcast:12 row_mask:0xf bank_mask:0xf
    v_and_b32_dpp v77, v63, v17 row_newbcast:12 row_mask:0xf bank_mask:0xf
    v_and_b32_dpp v78, v63, v18 row_newbcast:12 row_mask:0xf bank_mask:0xf
    v_and_b32_dpp v79, v63, v19 row_newbcast:12 row_mask:0xf bank_mask:0xf
    s_waitcnt vmcnt(10)
    v_mfma_f32_16x16x32_bf16 v[80:83], v[72:75], v[192:195], v[80:83]
    buffer_load_dwordx4 v[192:195], v3, s[32:35], s68 offen offset:2048 nt
    v_and_b32_dpp v72, v64, v16 row_newbcast:0 row_mask:0xf bank_mask:0xf
    v_and_b32_dpp v73, v64, v17 row_newbcast:0 row_mask:0xf bank_mask:0xf
    v_and_b32_dpp v74, v64, v18 row_newbcast:0 row_mask:0xf bank_mask:0xf
    v_and_b32_dpp v75, v64, v19 row_newbcast:0 row_mask:0xf bank_mask:0xf
    v_mfma_f32_16x16x32_bf16 v[80:83], v[76:79], v[180:183], v[80:83]
    buffer_load_dwordx4 v[180:183], v3, s[32:35], s68 offen offset:3072 nt
    v_and_b32_dpp v76, v64, v16 row_newbcast:4 row_mask:0xf bank_mask:0xf
    v_and_b32_dpp v77, v64, v17 row_newbcast:4 row_mask:0xf bank_mask:0xf
    v_and_b32_dpp v78, v64, v18 row_newbcast:4 row_mask:0xf bank_mask:0xf
    v_and_b32_dpp v79, v64, v19 row_newbcast:4 row_mask:0xf bank_mask:0xf
    s_waitcnt vmcnt(10)
    v_mfma_f32_16x16x32_bf16 v[80:83], v[72:75], v[184:187], v[80:83]
    buffer_load_dwordx4 v[184:187], v3, s[32:35], s69 offen offset:0 nt
    v_and_b32_dpp v72, v64, v16 row_newbcast:8 row_mask:0xf bank_mask:0xf
    v_and_b32_dpp v73, v64, v17 row_newbcast:8 row_mask:0xf bank_mask:0xf
    v_and_b32_dpp v74, v64, v18 row_newbcast:8 row_mask:0xf bank_mask:0xf
    v_and_b32_dpp v75, v64, v19 row_newbcast:8 row_mask:0xf bank_mask:0xf
    v_mfma_f32_16x16x32_bf16 v[80:83], v[76:79], v[140:143], v[80:83]
    buffer_load_dwordx4 v[140:143], v3, s[32:35], s69 offen offset:1024 nt
    s_cmp_eq_u32 s56, 5
    s_cbranch_scc0 L_role8
    buffer_load_dwordx2 v[14:15], v12, s[52:55], 0 offen sc0 sc1
L_role8:
    v_and_b32_dpp v76, v64, v16 row_newbcast:12 row_mask:0xf bank_mask:0xf
    v_and_b32_dpp v77, v64, v17 row_newbcast:12 row_mask:0xf bank_mask:0xf
    v_and_b32_dpp v78, v64, v18 row_newbcast:12 row_mask:0xf bank_mask:0xf
    v_and_b32_dpp v79, v64, v19 row_newbcast:12 row_mask:0xf bank_mask:0xf
    s_waitcnt vmcnt(10)
    v_mfma_f32_16x16x32_bf16 v[80:83], v[72:75], v[144:147], v[80:83]
    buffer_load_dwordx4 v[144:147], v3, s[32:35], s69 offen offset:2048 nt
    v_and_b32_dpp v72, v65, v16 row_newbcast:0 row_mask:0xf bank_mask:0xf
    v_and_b32_dpp v73, v65, v17 row_newbcast:0 row_mask:0xf bank_mask:0xf
    v_and_b32_dpp v74, v65, v18 row_newbcast:0 row_mask:0xf bank_mask:0xf
    v_and_b32_dpp v75, v65, v19 row_newbcast:0 row_mask:0xf bank_mask:0xf
    v_mfma_f32_16x16x32_bf16 v[80:83], v[76:79], v[100:103], v[80:83]
    buffer_load_dwordx4 v[100:103], v3, s[32:35], s69 offen offset:3072 nt
    v_and_b32_dpp v76, v65, v16 row_newbcast:4 row_mask:0xf bank_mask:0xf
    v_and_b32_dpp v77, v65, v17 row_newbcast:4 row_mask:0xf bank_mask:0xf
    v_and_b32_dpp v78, v65, v18 row_newbcast:4 row_mask:0xf bank_mask:0xf
    v_and_b32_dpp v79, v65, v19 row_newbcast:4 row_mask:0xf bank_mask:0xf
    s_waitcnt vmcnt(10)
    v_mfma_f32_16x16x32_bf16 v[80:83], v[72:75], v[104:107], v[80:83]
    v_and_b32_dpp v72, v65, v16 row_newbcast:8 row_mask:0xf bank_mask:0xf
    v_and_b32_dpp v73, v65, v17 row_newbcast:8 row_mask:0xf bank_mask:0xf
    v_and_b32_dpp v74, v65, v18 row_newbcast:8 row_mask:0xf bank_mask:0xf
    v_and_b32_dpp v75, v65, v19 row_newbcast:8 row_mask:0xf bank_mask:0xf
    v_mfma_f32_16x16x32_bf16 v[80:83], v[76:79], v[156:159], v[80:83]
    v_and_b32_dpp v76, v65, v16 row_newbcast:12 row_mask:0xf bank_mask:0xf
    v_and_b32_dpp v77, v65, v17 row_newbcast:12 row_mask:0xf bank_mask:0xf
    v_and_b32_dpp v78, v65, v18 row_newbcast:12 row_mask:0xf bank_mask:0xf
    v_and_b32_dpp v79, v65, v19 row_newbcast:12 row_mask:0xf bank_mask:0xf
    s_waitcnt vmcnt(8)
    v_mfma_f32_16x16x32_bf16 v[80:83], v[72:75], v[160:163], v[80:83]
    v_and_b32_dpp v72, v66, v16 row_newbcast:0 row_mask:0xf bank_mask:0xf
    v_and_b32_dpp v73, v66, v17 row_newbcast:0 row_mask:0xf bank_mask:0xf
    v_and_b32_dpp v74, v66, v18 row_newbcast:0 row_mask:0xf bank_mask:0xf
    v_and_b32_dpp v75, v66, v19 row_newbcast:0 row_mask:0xf bank_mask:0xf
    v_mfma_f32_16x16x32_bf16 v[80:83], v[76:79], v[212:215], v[80:83]
    v_and_b32_dpp v76, v66, v16 row_newbcast:4 row_mask:0xf bank_mask:0xf
    v_and_b32_dpp v77, v66, v17 row_newbcast:4 row_mask:0xf bank_mask:0xf
    v_and_b32_dpp v78, v66, v18 row_newbcast:4 row_mask:0xf bank_mask:0xf
    v_and_b32_dpp v79, v66, v19 row_newbcast:4 row_mask:0xf bank_mask:0xf
    s_waitcnt vmcnt(6)
    v_mfma_f32_16x16x32_bf16 v[80:83], v[72:75], v[136:139], v[80:83]
    v_add_u32 v2, v87, v88
    v_and_b32 v3, 3, v1
    v_lshl_add_u32 v3, v3, 2, v85
    v_lshl_add_u32 v3, v84, 4, v3
    v_lshlrev_b32 v3, 2, v3
    v_add_u32 v3, 0x3000, v3
    s_mul_i32 s62, s56, 2560
    v_add_u32 v6, s62, v87
    v_mov_b32 v8, 0
    v_and_b32_dpp v72, v66, v16 row_newbcast:8 row_mask:0xf bank_mask:0xf
    v_and_b32_dpp v73, v66, v17 row_newbcast:8 row_mask:0xf bank_mask:0xf
    v_and_b32_dpp v74, v66, v18 row_newbcast:8 row_mask:0xf bank_mask:0xf
    v_and_b32_dpp v75, v66, v19 row_newbcast:8 row_mask:0xf bank_mask:0xf
    v_mfma_f32_16x16x32_bf16 v[80:83], v[76:79], v[188:191], v[80:83]
    v_and_b32_dpp v76, v66, v16 row_newbcast:12 row_mask:0xf bank_mask:0xf
    v_and_b32_dpp v77, v66, v17 row_newbcast:12 row_mask:0xf bank_mask:0xf
    v_and_b32_dpp v78, v66, v18 row_newbcast:12 row_mask:0xf bank_mask:0xf
    v_and_b32_dpp v79, v66, v19 row_newbcast:12 row_mask:0xf bank_mask:0xf
    s_waitcnt vmcnt(4)
    v_mfma_f32_16x16x32_bf16 v[80:83], v[72:75], v[192:195], v[80:83]
    v_and_b32_dpp v72, v67, v16 row_newbcast:0 row_mask:0xf bank_mask:0xf
    v_and_b32_dpp v73, v67, v17 row_newbcast:0 row_mask:0xf bank_mask:0xf
    v_and_b32_dpp v74, v67, v18 row_newbcast:0 row_mask:0xf bank_mask:0xf
    v_and_b32_dpp v75, v67, v19 row_newbcast:0 row_mask:0xf bank_mask:0xf
    v_mfma_f32_16x16x32_bf16 v[80:83], v[76:79], v[180:183], v[80:83]
    s_cmp_eq_u32 s56, 5
    s_cbranch_scc0 L_role9
    s_waitcnt vmcnt(2)
    s_mov_b32 s89, 0x100000
L_spin10:
    v_readfirstlane_b32 s65, v15
    s_nop 2
    s_cmp_lg_u32 s65, 0
    s_cbranch_scc1 L_spun10
    s_sub_u32 s89, s89, 1
    s_cmp_eq_u32 s89, 0
    s_cbranch_scc1 L_spun10
    s_sleep 8
    buffer_load_dwordx2 v[14:15], v12, s[52:55], 0 offen sc0 sc1
    s_waitcnt vmcnt(0)
    s_branch L_spin10
L_spun10:
    v_max_f32 v36, v10, v14
    v_sub_f32 v37, v10, v36
    v_sub_f32 v38, v14, v36
    v_mul_f32 v37, s84, v37
    v_mul_f32 v38, s84, v38
    v_exp_f32 v37, v37
    v_exp_f32 v38, v38
    v_mul_f32 v39, v37, v11
    v_fmac_f32 v39, v38, v15
    v_rcp_f32 v39, v39
    s_nop 0
    v_mul_f32 v37, v37, v39
    v_mov_b32 v91, 0
    s_mov_b32 exec_lo, 0x1
    s_mov_b32 exec_hi, 0x0
    ds_write_b32 v91, v37 offset:16448
    s_mov_b64 exec, -1
    s_waitcnt lgkmcnt(0)
L_role9:
    v_and_b32_dpp v76, v67, v16 row_newbcast:4 row_mask:0xf bank_mask:0xf
    v_and_b32_dpp v77, v67, v17 row_newbcast:4 row_mask:0xf bank_mask:0xf
    v_and_b32_dpp v78, v67, v18 row_newbcast:4 row_mask:0xf bank_mask:0xf
    v_and_b32_dpp v79, v67, v19 row_newbcast:4 row_mask:0xf bank_mask:0xf
    s_waitcnt vmcnt(2)
    v_mfma_f32_16x16x32_bf16 v[80:83], v[72:75], v[184:187], v[80:83]
    v_and_b32_dpp v72, v67, v16 row_newbcast:8 row_mask:0xf bank_mask:0xf
    v_and_b32_dpp v73, v67, v17 row_newbcast:8 row_mask:0xf bank_mask:0xf
    v_and_b32_dpp v74, v67, v18 row_newbcast:8 row_mask:0xf bank_mask:0xf
    v_and_b32_dpp v75, v67, v19 row_newbcast:8 row_mask:0xf bank_mask:0xf
    v_mfma_f32_16x16x32_bf16 v[80:83], v[76:79], v[140:143], v[80:83]
    v_and_b32_dpp v76, v67, v16 row_newbcast:12 row_mask:0xf bank_mask:0xf
    v_and_b32_dpp v77, v67, v17 row_newbcast:12 row_mask:0xf bank_mask:0xf
    v_and_b32_dpp v78, v67, v18 row_newbcast:12 row_mask:0xf bank_mask:0xf
    v_and_b32_dpp v79, v67, v19 row_newbcast:12 row_mask:0xf bank_mask:0xf
    s_waitcnt vmcnt(0)
    v_mfma_f32_16x16x32_bf16 v[80:83], v[72:75], v[144:147], v[80:83]
    v_mfma_f32_16x16x32_bf16 v[80:83], v[76:79], v[100:103], v[80:83]
    s_nop 7
    v_mul_f32 v80, v80, v9
    v_mul_f32 v81, v81, v9
    v_mul_f32 v82, v82, v9
    v_mul_f32 v83, v83, v9
    s_mov_b32 exec_lo, 0xffffffff
    s_mov_b32 exec_hi, 0x0
    ds_write_b128 v2, v[80:83] offset:12288
    s_mov_b64 exec, -1
    s_waitcnt lgkmcnt(0)
    s_barrier
    ds_read2st64_b32 v[36:37], v3 offset0:0 offset1:2
    ds_read2st64_b32 v[38:39], v3 offset0:4 offset1:6
    ds_read2st64_b32 v[40:41], v3 offset0:8 offset1:10
    ds_read2st64_b32 v[42:43], v3 offset0:12 offset1:14
    ds_read_b32 v68, v8 offset:16448
    s_waitcnt lgkmcnt(3)
    v_add_f32 v36, v36, v37
    v_add_f32 v38, v38, v39
    s_waitcnt lgkmcnt(1)
    v_add_f32 v40, v40, v41
    v_add_f32 v42, v42, v43
    v_add_f32 v36, v36, v38
    v_add_f32 v40, v40, v42
    v_add_f32 v36, v36, v40
    s_waitcnt lgkmcnt(0)
    v_mul_f32 v68, v68, v36
    v_cvt_pk_bf16_f32 v69, v68, v68
    s_nop 1
    v_and_b32_dpp v72, v69, v16 row_newbcast:0 row_mask:0xf bank_mask:0xf
    v_and_b32_dpp v73, v69, v17 row_newbcast:0 row_mask:0xf bank_mask:0xf
    v_and_b32_dpp v74, v69, v18 row_newbcast:0 row_mask:0xf bank_mask:0xf
    v_and_b32_dpp v75, v69, v19 row_newbcast:0 row_mask:0xf bank_mask:0xf
    v_and_b32_dpp v76, v69, v16 row_newbcast:1 row_mask:0xf bank_mask:0xf
    v_and_b32_dpp v77, v69, v17 row_newbcast:1 row_mask:0xf bank_mask:0xf
    v_and_b32_dpp v78, v69, v18 row_newbcast:1 row_mask:0xf bank_mask:0xf
    v_and_b32_dpp v79, v69, v19 row_newbcast:1 row_mask:0xf bank_mask:0xf
    v_and_b32_dpp v24, v69, v16 row_newbcast:2 row_mask:0xf bank_mask:0xf
    v_and_b32_dpp v25, v69, v17 row_newbcast:2 row_mask:0xf bank_mask:0xf
    v_and_b32_dpp v26, v69, v18 row_newbcast:2 row_mask:0xf bank_mask:0xf
    v_and_b32_dpp v27, v69, v19 row_newbcast:2 row_mask:0xf bank_mask:0xf
    v_and_b32_dpp v28, v69, v16 row_newbcast:3 row_mask:0xf bank_mask:0xf
    v_and_b32_dpp v29, v69, v17 row_newbcast:3 row_mask:0xf bank_mask:0xf
    v_and_b32_dpp v30, v69, v18 row_newbcast:3 row_mask:0xf bank_mask:0xf
    v_and_b32_dpp v31, v69, v19 row_newbcast:3 row_mask:0xf bank_mask:0xf
    v_mfma_f32_16x16x32_bf16 v[36:39], v[72:75], v[216:219], 0
    v_mfma_f32_16x16x32_bf16 v[40:43], v[72:75], v[124:127], 0
    v_mfma_f32_16x16x32_bf16 v[44:47], v[72:75], v[128:131], 0
    v_mfma_f32_16x16x32_bf16 v[48:51], v[72:75], v[196:199], 0
    v_mfma_f32_16x16x32_bf16 v[20:23], v[72:75], v[200:203], 0
    v_mfma_f32_16x16x32_bf16 v[36:39], v[76:79], v[172:175], v[36:39]
    v_mfma_f32_16x16x32_bf16 v[40:43], v[76:79], v[176:179], v[40:43]
    v_mfma_f32_16x16x32_bf16 v[44:47], v[76:79], v[148:151], v[44:47]
    v_mfma_f32_16x16x32_bf16 v[48:51], v[76:79], v[152:155], v[48:51]
    v_mfma_f32_16x16x32_bf16 v[20:23], v[76:79], v[92:95], v[20:23]
    v_mfma_f32_16x16x32_bf16 v[36:39], v[24:27], v[96:99], v[36:39]
    v_mfma_f32_16x16x32_bf16 v[40:43], v[24:27], v[164:167], v[40:43]
    v_mfma_f32_16x16x32_bf16 v[44:47], v[24:27], v[168:171], v[44:47]
    v_mfma_f32_16x16x32_bf16 v[48:51], v[24:27], v[108:111], v[48:51]
    v_mfma_f32_16x16x32_bf16 v[20:23], v[24:27], v[112:115], v[20:23]
    v_mfma_f32_16x16x32_bf16 v[36:39], v[28:31], v[116:119], v[36:39]
    v_mfma_f32_16x16x32_bf16 v[40:43], v[28:31], v[120:123], v[40:43]
    v_mfma_f32_16x16x32_bf16 v[44:47], v[28:31], v[204:207], v[44:47]
    v_mfma_f32_16x16x32_bf16 v[48:51], v[28:31], v[208:211], v[48:51]
    v_mfma_f32_16x16x32_bf16 v[20:23], v[28:31], v[132:135], v[20:23]
    s_mov_b32 exec_lo, 0xffffffff
    s_mov_b32 exec_hi, 0x0
    s_nop 1
    ds_write_b128 v6, v[36:39] offset:16896
    ds_write_b128 v6, v[40:43] offset:17408
    ds_write_b128 v6, v[44:47] offset:17920
    ds_write_b128 v6, v[48:51] offset:18432
    ds_write_b128 v6, v[20:23] offset:18944
    s_mov_b64 exec, -1
    s_waitcnt lgkmcnt(0)
    s_barrier
    s_cmp_ge_u32 s56, 5
    s_cbranch_scc1 L_end
    v_lshl_add_u32 v90, v1, 2, v88
    s_mul_i32 s62, s58, 2560
    s_add_u32 s62, s62, 0x1000
    v_add_u32 v91, s62, v90
    v_add_u32 v90, 0x4200, v90
    ds_read2st64_b32 v[52:53], v90 offset0:0 offset1:1
    ds_read2st64_b32 v[54:55], v90 offset0:10 offset1:11
    ds_read2st64_b32 v[56:57], v90 offset0:20 offset1:21
    ds_read2st64_b32 v[58:59], v90 offset0:30 offset1:31
    ds_read2st64_b32 v[60:61], v90 offset0:40 offset1:41
    ds_read2st64_b32 v[62:63], v90 offset0:50 offset1:51
    ds_read2st64_b32 v[64:65], v90 offset0:60 offset1:61
    ds_read2st64_b32 v[66:67], v90 offset0:70 offset1:71
    s_waitcnt lgkmcnt(6)
    v_add_f32 v52, v52, v54
    v_add_f32 v53, v53, v55
    s_waitcnt lgkmcnt(5)
    v_add_f32 v52, v52, v56
    v_add_f32 v53, v53, v57
    s_waitcnt lgkmcnt(4)
    v_add_f32 v52, v52, v58
    v_add_f32 v53, v53, v59
    s_waitcnt lgkmcnt(3)
    v_add_f32 v52, v52, v60
    v_add_f32 v53, v53, v61
    s_waitcnt lgkmcnt(2)
    v_add_f32 v52, v52, v62
    v_add_f32 v53, v53, v63
    s_waitcnt lgkmcnt(1)
    v_add_f32 v52, v52, v64
    v_add_f32 v53, v53, v65
    s_waitcnt lgkmcnt(0)
    v_add_f32 v52, v52, v66
    v_add_f32 v53, v53, v67
    buffer_atomic_add_f32 v52, v91, s[52:55], 0 offen sc1
    buffer_atomic_add_f32 v53, v91, s[52:55], 0 offen offset:256 sc1
    s_mul_i32 s62, s58, 5
    s_add_u32 s62, s62, s56
    s_lshl_b32 s62, s62, 7
    s_add_u32 s62, s62, 0x6000
    v_mov_b32 v15, s62
    v_mov_b32 v14, 1
    v_lshlrev_b32 v90, 8, v84
    v_lshl_add_u32 v90, v1, 1, v90
    s_movk_i32 s63, 10240
    s_waitcnt vmcnt(0)
    s_mov_b32 exec_lo, 0x1
    s_mov_b32 exec_hi, 0x0
    buffer_atomic_add v14, v15, s[52:55], 0 offen sc0 sc1
    s_mov_b64 exec, -1
    buffer_load_ushort v40, v90, s[48:51], 0 offen
    buffer_load_ushort v41, v90, s[48:51], 0 offen offset:128
    s_waitcnt vmcnt(2)
    v_readfirstlane_b32 s65, v14
    s_nop 2
    s_cmp_lg_u32 s65, 63
    s_cbranch_scc1 L_end
    buffer_load_dword v36, v91, s[52:55], 0 offen sc0 sc1
    buffer_load_dword v37, v91, s[52:55], 0 offen offset:256 sc0 sc1
    buffer_load_dword v38, v91, s[52:55], s63 offen sc0 sc1
    buffer_load_dword v39, v91, s[52:55], s63 offen offset:256 sc0 sc1
    s_waitcnt vmcnt(2)
    v_lshlrev_b32 v40, 16, v40
    v_lshlrev_b32 v41, 16, v41
    v_cvt_pk_bf16_f32 v42, v36, v37
    v_lshlrev_b32 v36, 16, v42
    v_and_b32 v37, 0xffff0000, v42
    v_add_f32 v36, v36, v40
    v_add_f32 v37, v37, v41
    v_cvt_pk_bf16_f32 v42, v36, v37
    v_lshlrev_b32 v36, 16, v42
    v_and_b32 v37, 0xffff0000, v42
    s_waitcnt vmcnt(0)
    v_cvt_pk_bf16_f32 v42, v38, v39
    v_lshlrev_b32 v38, 16, v42
    v_and_b32 v39, 0xffff0000, v42
    v_add_f32 v36, v36, v38
    v_add_f32 v37, v37, v39
    v_cvt_pk_bf16_f32 v42, v36, v37
    buffer_store_short v42, v90, s[36:39], 0 offen
    buffer_store_short_d16_hi v42, v90, s[36:39], 0 offen offset:128
L_end:
    s_endpgm
.p2align 8
.fill 4352, 4, 0xbf800000
.section .rodata,"a"
.p2align 6
.amdhsa_kernel parallel_sum__mha_block_cached__glu_gated_bilinear__decode_kernel
  .amdhsa_next_free_vgpr 220
  .amdhsa_next_free_sgpr 96
  .amdhsa_accum_offset 220
  .amdhsa_group_segment_fixed_size 0
  .amdhsa_kernarg_size 96
  .amdhsa_user_sgpr_count 2
  .amdhsa_user_sgpr_kernarg_segment_ptr 1
  .amdhsa_system_sgpr_workgroup_id_x 1
.end_amdhsa_kernel
```
